```python
import torch

def _softmax(x, axis=-1):
    return torch.softmax(x, dim=axis)
def _gelu(x):
    return torch.nn.functional.gelu(x, approximate="tanh")
def _silu(x):
    return torch.nn.functional.silu(x)
def _sigmoid(x):
    return torch.sigmoid(x)
def _layernorm(x, axis=-1, eps=1e-5):
    m = x.mean(dim=axis, keepdim=True)
    v = x.var(dim=axis, keepdim=True, unbiased=False)
    return (x - m) / torch.sqrt(v + eps)
def _scatter_add(tgt, idx, src, axis=0):
    return tgt.clone().index_add_(axis, idx, src)
def _segment_sum(src, seg, n):
    out = torch.zeros((n,) + src.shape[1:], dtype=src.dtype)
    return out.index_add_(0, seg, src)
def _pad(x, pw):
    flat = tuple(v for pair in reversed(pw) for v in pair)
    return torch.nn.functional.pad(x, flat)

kernel_name = 'parallel_sum__softmax_full_mha__dense_activation_relu__prompt'

def setup_inputs():

    _w = (lambda a: (lambda t: t.to(torch.bfloat16) if t.is_floating_point() else t)(torch.as_tensor(a)))
    def _A_setup():
        B, S, D = 1, 2048, 448
        return {
            "x": _w((lambda *s: torch.randn(*s, dtype=torch.bfloat16) * 0.05)(B, S, D)),
            "wqkv": _w((lambda *s: torch.randn(*s, dtype=torch.bfloat16) * 0.2)(D, 3 * D)),
            "wo": _w((lambda *s: torch.randn(*s, dtype=torch.bfloat16) * 0.1)(D, D)),
        }
    _A_in = _A_setup()

    def _B_setup():
        B, S, D, Dff = 1, 2048, 448, 1792
        return {
            "x": _w((lambda *s: torch.randn(*s, dtype=torch.bfloat16) * 0.05)(B, S, D)),
            "w1": _w((lambda *s: torch.randn(*s, dtype=torch.bfloat16) * 0.2)(D, Dff)),
            "w2": _w((lambda *s: torch.randn(*s, dtype=torch.bfloat16) * 0.2)(Dff, D)),
        }
    _B_in = _B_setup()

    return {
        "A_x": _A_in["x"],
        "A_wqkv": _A_in["wqkv"],
        "A_wo": _A_in["wo"],
        "B_x": _B_in["x"],
        "B_w1": _B_in["w1"],
        "B_w2": _B_in["w2"],
    }

def reference(A_x, A_wqkv, A_wo, B_x, B_w1, B_w2):
    def _A_ref(x, wqkv, wo):
        B, S, D = x.shape
        H = 16; Dh = D // H
        qkv = (lambda x, *d: x.permute(*d))((x @ wqkv).reshape(B, S, 3, H, Dh), 2, 0, 3, 1, 4)
        q, k, v = qkv[0], qkv[1], qkv[2]
        scale = Dh ** -0.5
        scores = torch.einsum("bhqd,bhkd->bhqk", q, k) * scale
        p = _softmax(scores, axis=-1)
        o = torch.einsum("bhqk,bhkd->bhqd", p, v)
        return (lambda x, *d: x.permute(*d))(o, 0, 2, 1, 3).reshape(B, S, D) @ wo

    def _B_ref(x, w1, w2):
        h = torch.einsum("bsd,df->bsf", x, w1)
        zero = torch.zeros_like(h)
        h = torch.maximum(h, zero)
        return torch.einsum("bsf,fd->bsd", h, w2)

    x = A_x
    xn = _layernorm(x, axis=-1)
    return x + _A_ref(xn, A_wqkv, A_wo) + _B_ref(xn, B_w1, B_w2)
```

```asm
; @launch grid=(256,1,1) block=(512,1,1) lds=163840
.amdgcn_target "amdgcn-amd-amdhsa--gfx950"
.text
.globl parallel_sum__softmax_full_mha__dense_activation_relu__prompt_kernel
.p2align 8
.type parallel_sum__softmax_full_mha__dense_activation_relu__prompt_kernel,@function
parallel_sum__softmax_full_mha__dense_activation_relu__prompt_kernel:
ENTRY:
    s_load_dwordx16 s[4:19], s[0:1], 0
    s_load_dwordx2 s[20:21], s[0:1], 64
    s_cmp_ge_u32 s2, 256
    s_cbranch_scc1 END
    v_lshrrev_b32 v3, 6, v0
    v_and_b32 v0, 63, v0
    v_readfirstlane_b32 s48, v3
    s_cmp_ge_u32 s2, 224
    s_cbranch_scc1 SPARE
    s_and_b32 s53, s2, 3
    s_lshl_b32 s53, s53, 2
    s_bfe_u32 s54, s2, 0x20003
    s_add_u32 s50, s53, s54
    s_and_b32 s49, s48, 3
    s_lshl_b32 s52, s50, 2
    s_add_u32 s52, s52, s49
    s_lshl_b32 s57, s49, 12
    s_bfe_u32 s60, s2, 0x10002
    s_mul_i32 s53, s60, 7
    s_lshr_b32 s59, s2, 5
    s_add_u32 s51, s53, s59
    s_and_b32 s53, s2, 3
    s_add_u32 s40, s54, s59
    s_and_b32 s40, s40, 1
    s_lshl_b32 s40, s40, 2
    s_add_u32 s40, s40, s53
    s_lshl_b32 s53, s60, 1
    s_add_u32 s40, s40, s53
    s_cmp_ge_u32 s40, 7
    s_cselect_b32 s53, 7, 0
    s_sub_u32 s40, s40, s53
    s_cmp_lt_u32 s48, 4
    s_cbranch_scc1 A_ENTRY
    s_setprio 2
    s_lshl_b32 s53, s52, 5
    v_lshrrev_b32 v3, 3, v0
    v_add_u32 v3, s53, v3
    v_mul_u32_u24 v3, 896, v3
    v_and_b32 v4, 7, v0
    v_lshrrev_b32 v5, 4, v0
    v_xor_b32 v4, v4, v5
    v_lshl_add_u32 v240, v4, 4, v3
    v_xor_b32 v241, 64, v240
    v_add_u32 v241, 6144, v241
    v_add_u32 v242, 12288, v240
    v_add_u32 v243, 12288, v241
    s_mul_i32 s53, s49, 192
    s_lshl_b32 s54, s51, 7
    s_lshl_b32 s55, s51, 6
    s_add_u32 s55, s55, 1664
    v_mov_b32 v8, s55
    v_mov_b32 v9, s54
    v_add_u32 v3, s53, v0
    v_mul_u32_u24 v4, 43691, v3
    v_lshrrev_b32 v4, 19, v4
    v_mul_u32_u24 v5, 12, v4
    v_sub_u32 v5, v3, v5
    v_cmp_gt_u32 vcc, 8, v5
    v_mul_u32_u24 v4, 2688, v4
    v_lshl_add_u32 v4, v5, 4, v4
    v_cndmask_b32 v6, v8, v9, vcc
    v_add_u32 v244, v4, v6
    v_add_u32 v3, s53, v0
    v_add_u32 v3, 64, v3
    s_waitcnt lgkmcnt(0)
    s_mov_b32 s24, s4
    s_mov_b32 s25, s5
    s_mov_b32 s26, 1835008
    s_mov_b32 s27, 0x00020000
    s_mov_b32 s28, s6
    s_mov_b32 s29, s7
    s_mov_b32 s30, 1204224
    s_mov_b32 s31, 0x00020000
    s_add_u32 m0, s57, 0
    s_lshl_b32 s56, s40, 7
    buffer_load_dwordx4 v240, s[24:27], s56 offen offset:0 lds
    v_mul_u32_u24 v4, 43691, v3
    v_lshrrev_b32 v4, 19, v4
    v_mul_u32_u24 v5, 12, v4
    v_sub_u32 v5, v3, v5
    v_cmp_gt_u32 vcc, 8, v5
    v_mul_u32_u24 v4, 2688, v4
    v_lshl_add_u32 v4, v5, 4, v4
    buffer_load_dwordx4 v241, s[24:27], s56 offen offset:1024 lds
    v_cndmask_b32 v6, v8, v9, vcc
    v_add_u32 v4, -1024, v4
    v_add_u32 v245, v4, v6
    v_add_u32 v3, s53, v0
    v_add_u32 v3, 128, v3
    v_mul_u32_u24 v4, 43691, v3
    buffer_load_dwordx4 v242, s[24:27], s56 offen offset:2048 lds
    v_lshrrev_b32 v4, 19, v4
    v_mul_u32_u24 v5, 12, v4
    v_sub_u32 v5, v3, v5
    v_cmp_gt_u32 vcc, 8, v5
    v_mul_u32_u24 v4, 2688, v4
    v_lshl_add_u32 v4, v5, 4, v4
    buffer_load_dwordx4 v243, s[24:27], s56 offen offset:3072 lds
    v_cndmask_b32 v6, v8, v9, vcc
    v_add_u32 v4, -2048, v4
    v_add_u32 v246, v4, v6
    s_mul_i32 s58, s49, 3072
    s_add_u32 s58, s58, 114688
    s_add_u32 s41, s40, 1
    s_cmp_eq_u32 s41, 7
    s_cselect_b32 s41, 0, s41
    s_add_u32 s42, s41, 1
    s_cmp_eq_u32 s42, 7
    s_cselect_b32 s42, 0, s42
    s_add_u32 s43, s42, 1
    s_cmp_eq_u32 s43, 7
    s_cselect_b32 s43, 0, s43
    s_add_u32 s44, s43, 1
    s_cmp_eq_u32 s44, 7
    s_cselect_b32 s44, 0, s44
    s_add_u32 s45, s44, 1
    s_cmp_eq_u32 s45, 7
    s_cselect_b32 s45, 0, s45
    s_add_u32 s46, s45, 1
    s_cmp_eq_u32 s46, 7
    s_cselect_b32 s46, 0, s46
    s_add_u32 m0, s58, 0
    s_mul_i32 s56, s40, 172032
    buffer_load_dwordx4 v244, s[28:31], s56 offen offset:0 lds
    s_mov_b32 s32, s12
    s_mov_b32 s33, s13
    s_mov_b32 s34, 1605632
    s_mov_b32 s35, 0x00020000
    buffer_load_dwordx4 v245, s[28:31], s56 offen offset:1024 lds
    s_mov_b32 s36, s20
    s_mov_b32 s37, s21
    s_mov_b32 s38, 268435456
    s_mov_b32 s39, 0x00020000
    buffer_load_dwordx4 v246, s[28:31], s56 offen offset:2048 lds
    v_mov_b32 v14, 19136512
    buffer_load_dword v14, v14, s[36:39], 0 offen sc1
    v_and_b32 v1, 31, v0
    s_add_u32 m0, s57, 16384
    s_lshl_b32 s56, s41, 7
    buffer_load_dwordx4 v240, s[24:27], s56 offen offset:0 lds
    v_lshrrev_b32 v2, 5, v0
    s_mov_b32 s3, 0x3f803f80
    v_bfe_u32 v3, v1, 1, 3
    v_xor_b32 v3, v3, v2
    buffer_load_dwordx4 v241, s[24:27], s56 offen offset:1024 lds
    v_lshlrev_b32 v4, 7, v1
    v_lshl_add_u32 v4, v3, 4, v4
    v_add_u32 v248, s57, v4
    v_xor_b32 v249, 32, v248
    buffer_load_dwordx4 v242, s[24:27], s56 offen offset:2048 lds
    v_xor_b32 v250, 64, v248
    v_xor_b32 v251, 96, v248
    v_lshrrev_b32 v3, 2, v0
    buffer_load_dwordx4 v243, s[24:27], s56 offen offset:3072 lds
    v_xor_b32 v3, v3, v0
    v_bfe_u32 v3, v3, 2, 1
    v_add_u32 v3, -1, v3
    v_and_b32 v128, s3, v3
    s_add_u32 m0, s58, 12288
    s_mul_i32 s56, s41, 172032
    buffer_load_dwordx4 v244, s[28:31], s56 offen offset:0 lds
    v_mov_b32 v129, v128
    v_mov_b32 v130, v128
    v_mov_b32 v131, v128
    s_lshl_b32 s53, s49, 4
    buffer_load_dwordx4 v245, s[28:31], s56 offen offset:1024 lds
    v_lshrrev_b32 v3, 4, v0
    v_add_u32 v4, s53, v3
    v_mul_u32_u24 v4, 3584, v4
    buffer_load_dwordx4 v246, s[28:31], s56 offen offset:2048 lds
    v_bfe_u32 v5, v0, 2, 2
    v_xor_b32 v6, v5, v3
    v_lshl_add_u32 v4, v6, 6, v4
    v_and_b32 v7, 3, v0
    s_add_u32 m0, s57, 32768
    s_lshl_b32 s56, s42, 7
    buffer_load_dwordx4 v240, s[24:27], s56 offen offset:0 lds
    v_lshl_add_u32 v4, v7, 4, v4
    s_lshl_b32 s53, s51, 8
    v_add_u32 v252, s53, v4
    v_bfe_u32 v8, v0, 4, 1
    buffer_load_dwordx4 v241, s[24:27], s56 offen offset:1024 lds
    v_lshlrev_b32 v8, 5, v8
    v_lshl_add_u32 v8, v7, 3, v8
    v_lshl_add_u32 v9, v2, 3, v5
    buffer_load_dwordx4 v242, s[24:27], s56 offen offset:2048 lds
    v_lshl_add_u32 v7, v9, 8, v8
    v_lshl_add_u32 v10, v5, 6, v7
    s_lshl_b32 s53, s49, 6
    v_xor_b32 v10, s53, v10
    buffer_load_dwordx4 v243, s[24:27], s56 offen offset:3072 lds
    v_xor_b32 v11, 64, v10
    v_xor_b32 v12, 128, v10
    v_xor_b32 v13, 192, v10
    s_waitcnt vmcnt(15)
    ds_read_b128 v[16:19], v248 offset:0
    ds_read_b128 v[20:23], v249 offset:0
    ds_read_b128 v[24:27], v250 offset:0
    ds_read_b128 v[28:31], v251 offset:0
    s_waitcnt vmcnt(7)
    s_barrier
    ds_read_b128 v[32:35], v248 offset:16384
    ds_read_b128 v[36:39], v249 offset:16384
    ds_read_b128 v[40:43], v250 offset:16384
    ds_read_b128 v[44:47], v251 offset:16384
    s_add_u32 m0, s58, 24576
    s_mul_i32 s56, s42, 172032
    buffer_load_dwordx4 v244, s[28:31], s56 offen offset:0 lds
    buffer_load_dwordx4 v245, s[28:31], s56 offen offset:1024 lds
    buffer_load_dwordx4 v246, s[28:31], s56 offen offset:2048 lds
    s_add_u32 m0, s57, 49152
    s_lshl_b32 s56, s43, 7
    buffer_load_dwordx4 v240, s[24:27], s56 offen offset:0 lds
    buffer_load_dwordx4 v241, s[24:27], s56 offen offset:1024 lds
    buffer_load_dwordx4 v242, s[24:27], s56 offen offset:2048 lds
    buffer_load_dwordx4 v243, s[24:27], s56 offen offset:3072 lds
    s_waitcnt lgkmcnt(0)
    s_waitcnt vmcnt(7)
    s_barrier
    ds_read_b128 v[48:51], v248 offset:32768
    ds_read_b128 v[52:55], v249 offset:32768
    ds_read_b128 v[56:59], v250 offset:32768
    ds_read_b128 v[60:63], v251 offset:32768
    s_add_u32 m0, s58, 36864
    s_mul_i32 s56, s43, 172032
    buffer_load_dwordx4 v244, s[28:31], s56 offen offset:0 lds
    buffer_load_dwordx4 v245, s[28:31], s56 offen offset:1024 lds
    buffer_load_dwordx4 v246, s[28:31], s56 offen offset:2048 lds
    s_lshl_b32 s53, s52, 9
    s_add_u32 s53, s53, 19202048
    s_add_u32 m0, s57, 65536
    s_lshl_b32 s56, s44, 7
    buffer_load_dwordx4 v240, s[24:27], s56 offen offset:0 lds
    v_lshl_add_u32 v196, v1, 4, s53
    s_lshl_b32 s53, s49, 7
    buffer_load_dwordx4 v241, s[24:27], s56 offen offset:1024 lds
    s_add_u32 s53, s53, 159744
    v_lshl_add_u32 v197, v1, 2, s53
    buffer_load_dwordx4 v242, s[24:27], s56 offen offset:2048 lds
    s_lshl_b32 s53, s49, 9
    s_add_u32 s53, s53, 154624
    buffer_load_dwordx4 v243, s[24:27], s56 offen offset:3072 lds
    v_lshl_add_u32 v198, v0, 2, s53
    v_add_u32 v199, -1, v2
    s_waitcnt lgkmcnt(0)
    s_waitcnt vmcnt(7)
    s_barrier
    ds_read_b128 v[64:67], v248 offset:49152
    ds_read_b128 v[68:71], v249 offset:49152
    ds_read_b128 v[72:75], v250 offset:49152
    ds_read_b128 v[76:79], v251 offset:49152
    s_add_u32 m0, s58, 0
    s_mul_i32 s56, s44, 172032
    buffer_load_dwordx4 v244, s[28:31], s56 offen offset:0 lds
    buffer_load_dwordx4 v245, s[28:31], s56 offen offset:1024 lds
    buffer_load_dwordx4 v246, s[28:31], s56 offen offset:2048 lds
    v_readfirstlane_b32 s62, v14
    s_nop 0
    s_add_u32 m0, s57, 81920
    s_lshl_b32 s56, s45, 7
    buffer_load_dwordx4 v240, s[24:27], s56 offen offset:0 lds
    s_mul_i32 s62, s62, 1664525
    buffer_load_dwordx4 v241, s[24:27], s56 offen offset:1024 lds
    s_add_u32 s62, s62, 1013904223
    buffer_load_dwordx4 v242, s[24:27], s56 offen offset:2048 lds
    s_mul_i32 s63, s62, 0x9E3779B1
    buffer_load_dwordx4 v243, s[24:27], s56 offen offset:3072 lds
    s_xor_b32 s63, s63, 0x5bd1e995
    s_waitcnt lgkmcnt(0)
    s_waitcnt vmcnt(7)
    s_barrier
    v_add_u32 v248, 0x10000, v248
    v_add_u32 v249, 0x10000, v249
    v_add_u32 v250, 0x10000, v250
    v_add_u32 v251, 0x10000, v251
    ds_read_b128 v[80:83], v248 offset:0
    ds_read_b128 v[84:87], v249 offset:0
    ds_read_b128 v[88:91], v250 offset:0
    ds_read_b128 v[92:95], v251 offset:0
    s_add_u32 m0, s58, 12288
    s_mul_i32 s56, s45, 172032
    buffer_load_dwordx4 v244, s[28:31], s56 offen offset:0 lds
    buffer_load_dwordx4 v245, s[28:31], s56 offen offset:1024 lds
    buffer_load_dwordx4 v246, s[28:31], s56 offen offset:2048 lds
    s_mul_i32 s53, s49, 448
    v_lshrrev_b32 v3, 3, v0
    v_add_u32 v4, s53, v3
    s_add_u32 m0, s57, 98304
    s_lshl_b32 s56, s46, 7
    buffer_load_dwordx4 v240, s[24:27], s56 offen offset:0 lds
    v_mul_u32_u24 v4, 896, v4
    v_lshrrev_b32 v5, 2, v0
    v_and_b32 v5, 4, v5
    buffer_load_dwordx4 v241, s[24:27], s56 offen offset:1024 lds
    v_and_b32 v6, 7, v0
    v_xor_b32 v5, v5, v6
    v_lshl_add_u32 v4, v5, 4, v4
    buffer_load_dwordx4 v242, s[24:27], s56 offen offset:2048 lds
    s_lshl_b32 s53, s59, 7
    v_add_u32 v14, s53, v4
    v_add_u32 v15, 6144, v14
    buffer_load_dwordx4 v243, s[24:27], s56 offen offset:3072 lds
    s_lshl_b32 s47, s49, 13
    s_add_u32 s47, s47, 114688
    s_waitcnt lgkmcnt(0)
    s_waitcnt vmcnt(7)
    s_barrier
    ds_read_b128 v[96:99], v248 offset:16384
    ds_read_b128 v[100:103], v249 offset:16384
    ds_read_b128 v[104:107], v250 offset:16384
    ds_read_b128 v[108:111], v251 offset:16384
    buffer_load_dwordx4 v[192:195], v196, s[36:39], 0 offen sc1
    s_add_u32 m0, s58, 24576
    s_mul_i32 s56, s46, 172032
    buffer_load_dwordx4 v244, s[28:31], s56 offen offset:0 lds
    buffer_load_dwordx4 v245, s[28:31], s56 offen offset:1024 lds
    v_lshlrev_b32 v3, 2, v0
    s_lshl_b32 s53, s49, 8
    s_add_u32 s53, s53, 156672
    buffer_load_dwordx4 v246, s[28:31], s56 offen offset:2048 lds
    v_add_u32 v4, s53, v3
    v_mov_b32 v5, -1
    s_add_u32 m0, s57, 0
    s_mul_i32 s56, s40, 229376
    s_add_u32 s56, s56, 0
    buffer_load_dwordx4 v252, s[32:35], s56 offen offset:0 lds
    ds_write_b32 v4, v5
    ds_write_b32 v4, v5 offset:1024
    s_add_u32 m0, s57, 0
    s_mul_i32 s56, s40, 229376
    s_add_u32 s56, s56, 13312
    buffer_load_dwordx4 v252, s[32:35], s56 offen offset:1024 lds
    v_add_u32 v4, 158720, v3
    v_cmp_gt_u32 vcc, 4, v0
    v_mov_b32 v6, 0
    s_add_u32 m0, s57, 0
    s_mul_i32 s56, s40, 229376
    s_add_u32 s56, s56, 26624
    buffer_load_dwordx4 v252, s[32:35], s56 offen offset:2048 lds
    s_nop 0
    v_cndmask_b32 v5, v5, v6, vcc
    s_add_u32 m0, s57, 0
    s_mul_i32 s56, s40, 229376
    s_add_u32 s56, s56, 39936
    buffer_load_dwordx4 v252, s[32:35], s56 offen offset:3072 lds
    ds_write_b32 v4, v5
    s_waitcnt lgkmcnt(0)
    s_waitcnt lgkmcnt(0)
    s_waitcnt vmcnt(8)
    s_barrier
    ds_read_b128 v[112:115], v248 offset:32768
    ds_read_b128 v[116:119], v249 offset:32768
    ds_read_b128 v[120:123], v250 offset:32768
    ds_read_b128 v[124:127], v251 offset:32768
    s_add_u32 m0, s57, 16384
    s_mul_i32 s56, s41, 229376
    s_add_u32 s56, s56, 0
    buffer_load_dwordx4 v252, s[32:35], s56 offen offset:0 lds
    s_add_u32 m0, s57, 16384
    s_mul_i32 s56, s41, 229376
    s_add_u32 s56, s56, 13312
    buffer_load_dwordx4 v252, s[32:35], s56 offen offset:1024 lds
    s_add_u32 m0, s57, 16384
    s_mul_i32 s56, s41, 229376
    s_add_u32 s56, s56, 26624
    buffer_load_dwordx4 v252, s[32:35], s56 offen offset:2048 lds
    s_add_u32 m0, s57, 16384
    s_mul_i32 s56, s41, 229376
    s_add_u32 s56, s56, 39936
    buffer_load_dwordx4 v252, s[32:35], s56 offen offset:3072 lds
    s_add_u32 m0, s57, 32768
    s_mul_i32 s56, s42, 229376
    s_add_u32 s56, s56, 0
    buffer_load_dwordx4 v252, s[32:35], s56 offen offset:0 lds
    s_add_u32 m0, s57, 32768
    s_mul_i32 s56, s42, 229376
    s_add_u32 s56, s56, 13312
    buffer_load_dwordx4 v252, s[32:35], s56 offen offset:1024 lds
    s_add_u32 m0, s57, 32768
    s_mul_i32 s56, s42, 229376
    s_add_u32 s56, s56, 26624
    buffer_load_dwordx4 v252, s[32:35], s56 offen offset:2048 lds
    s_waitcnt lgkmcnt(0)
    s_waitcnt vmcnt(11)
    s_barrier
    s_mov_b32 s61, 40000
    s_waitcnt vmcnt(14)
SC_1:
    v_cmp_ne_u64 vcc, s[62:63], v[194:195]
    s_cbranch_vccz SCD_2
    buffer_load_dwordx4 v[192:195], v196, s[36:39], 0 offen sc1
    s_sub_u32 s61, s61, 1
    s_cmp_lg_u32 s61, 0
    s_waitcnt vmcnt(0)
    s_cbranch_scc1 SC_1
SCD_2:
    v_and_b32 v240, v199, v193
    ds_write_b32 v197, v192
    ds_write_b32 v198, v240
    v_mov_b32 v241, 0
    v_mov_b32 v242, 0
    v_mov_b32 v243, 0
    s_add_u32 m0, s57, 32768
    s_mul_i32 s56, s42, 229376
    s_add_u32 s56, s56, 39936
    buffer_load_dwordx4 v252, s[32:35], s56 offen offset:3072 lds
    s_add_u32 m0, s57, 49152
    s_mul_i32 s56, s43, 229376
    s_add_u32 s56, s56, 0
    buffer_load_dwordx4 v252, s[32:35], s56 offen offset:0 lds
    s_add_u32 m0, s57, 49152
    s_mul_i32 s56, s43, 229376
    s_add_u32 s56, s56, 13312
    buffer_load_dwordx4 v252, s[32:35], s56 offen offset:1024 lds
    s_add_u32 m0, s57, 49152
    s_mul_i32 s56, s43, 229376
    s_add_u32 s56, s56, 26624
    buffer_load_dwordx4 v252, s[32:35], s56 offen offset:2048 lds
    s_add_u32 m0, s57, 49152
    s_mul_i32 s56, s43, 229376
    s_add_u32 s56, s56, 39936
    buffer_load_dwordx4 v252, s[32:35], s56 offen offset:3072 lds
    s_add_u32 m0, s57, 65536
    s_mul_i32 s56, s44, 229376
    s_add_u32 s56, s56, 0
    buffer_load_dwordx4 v252, s[32:35], s56 offen offset:0 lds
    s_add_u32 m0, s57, 65536
    s_mul_i32 s56, s44, 229376
    s_add_u32 s56, s56, 13312
    buffer_load_dwordx4 v252, s[32:35], s56 offen offset:1024 lds
    s_waitcnt lgkmcnt(0)
    v_mov_b32 v244, v128
    v_mov_b32 v245, v128
    v_mov_b32 v246, v128
    v_mov_b32 v247, v128
    s_lshl_b32 s53, s49, 2
    s_add_u32 s53, s53, 158720
    v_mov_b32 v253, s53
    v_and_b32 v254, 3, v0
    v_lshlrev_b32 v254, 2, v254
    v_add_u32 v254, 158720, v254
    v_mov_b32 v255, 0
    s_barrier
    s_setprio 0
    s_add_u32 m0, s57, 65536
    s_mul_i32 s56, s44, 229376
    s_add_u32 s56, s56, 26624
    buffer_load_dwordx4 v252, s[32:35], s56 offen offset:2048 lds
    s_add_u32 m0, s57, 65536
    s_mul_i32 s56, s44, 229376
    s_add_u32 s56, s56, 39936
    buffer_load_dwordx4 v252, s[32:35], s56 offen offset:3072 lds
    s_add_u32 m0, s57, 81920
    s_mul_i32 s56, s45, 229376
    s_add_u32 s56, s56, 0
    buffer_load_dwordx4 v252, s[32:35], s56 offen offset:0 lds
    s_add_u32 m0, s57, 81920
    s_mul_i32 s56, s45, 229376
    s_add_u32 s56, s56, 13312
    buffer_load_dwordx4 v252, s[32:35], s56 offen offset:1024 lds
    s_add_u32 m0, s57, 81920
    s_mul_i32 s56, s45, 229376
    s_add_u32 s56, s56, 26624
    buffer_load_dwordx4 v252, s[32:35], s56 offen offset:2048 lds
    s_add_u32 m0, s57, 81920
    s_mul_i32 s56, s45, 229376
    s_add_u32 s56, s56, 39936
    buffer_load_dwordx4 v252, s[32:35], s56 offen offset:3072 lds
    s_add_u32 m0, s57, 98304
    s_mul_i32 s56, s46, 229376
    s_add_u32 s56, s56, 0
    buffer_load_dwordx4 v252, s[32:35], s56 offen offset:0 lds
    s_add_u32 m0, s57, 98304
    s_mul_i32 s56, s46, 229376
    s_add_u32 s56, s56, 13312
    buffer_load_dwordx4 v252, s[32:35], s56 offen offset:1024 lds
    s_add_u32 m0, s57, 98304
    s_mul_i32 s56, s46, 229376
    s_add_u32 s56, s56, 26624
    buffer_load_dwordx4 v252, s[32:35], s56 offen offset:2048 lds
    s_add_u32 m0, s57, 98304
    s_mul_i32 s56, s46, 229376
    s_add_u32 s56, s56, 39936
    buffer_load_dwordx4 v252, s[32:35], s56 offen offset:3072 lds
    s_mov_b32 s32, s14
    s_mov_b32 s33, s15
    s_mov_b32 s34, 1605632
    s_waitcnt vmcnt(20)
    ds_write_b32 v253, v255 offset:64
    s_mov_b32 s61, 320000
LS_3:
    ds_read_b32 v3, v254 offset:64
    s_waitcnt lgkmcnt(0)
    v_cmp_eq_u32 vcc, -1, v3
    s_cbranch_vccz LSD_4
    s_sub_u32 s61, s61, 1
    s_cmp_lg_u32 s61, 0
    s_cbranch_scc1 LS_3
LSD_4:
    ds_read_b64_tr_b16 v[192:193], v10 offset:0
    ds_read_b64_tr_b16 v[194:195], v10 offset:1024
    ds_read_b64_tr_b16 v[196:197], v11 offset:0
    ds_read_b64_tr_b16 v[198:199], v11 offset:1024
    ds_read_b64_tr_b16 v[200:201], v12 offset:0
    ds_read_b64_tr_b16 v[202:203], v12 offset:1024
    ds_read_b64_tr_b16 v[204:205], v13 offset:0
    ds_read_b64_tr_b16 v[206:207], v13 offset:1024
    ds_read_b64_tr_b16 v[208:209], v10 offset:4096
    ds_read_b64_tr_b16 v[210:211], v10 offset:5120
    ds_read_b64_tr_b16 v[212:213], v11 offset:4096
    ds_read_b64_tr_b16 v[214:215], v11 offset:5120
    ds_read_b64_tr_b16 v[216:217], v12 offset:4096
    ds_read_b64_tr_b16 v[218:219], v12 offset:5120
    ds_read_b64_tr_b16 v[220:221], v13 offset:4096
    ds_read_b64_tr_b16 v[222:223], v13 offset:5120
    s_waitcnt lgkmcnt(8)
    v_mfma_f32_16x16x32_bf16 v[248:251], v[244:247], v[192:195], 0
    ds_read_b64_tr_b16 v[224:225], v10 offset:8192
    ds_read_b64_tr_b16 v[226:227], v10 offset:9216
    v_mfma_f32_32x32x16_bf16 v[128:143], v[192:195], v[16:19], 0
    ds_read_b64_tr_b16 v[228:229], v11 offset:8192
    ds_read_b64_tr_b16 v[230:231], v11 offset:9216
    v_mfma_f32_32x32x16_bf16 v[144:159], v[196:199], v[16:19], 0
    ds_read_b64_tr_b16 v[232:233], v12 offset:8192
    v_mfma_f32_32x32x16_bf16 v[160:175], v[200:203], v[16:19], 0
    ds_read_b64_tr_b16 v[234:235], v12 offset:9216
    ds_read_b64_tr_b16 v[236:237], v13 offset:8192
    v_mfma_f32_32x32x16_bf16 v[176:191], v[204:207], v[16:19], 0
    ds_read_b64_tr_b16 v[238:239], v13 offset:9216
    s_waitcnt lgkmcnt(8)
    v_mfma_f32_16x16x32_bf16 v[248:251], v[244:247], v[208:211], v[248:251]
    ds_read_b64_tr_b16 v[192:193], v10 offset:12288
    ds_read_b64_tr_b16 v[194:195], v10 offset:13312
    v_mfma_f32_32x32x16_bf16 v[128:143], v[208:211], v[20:23], v[128:143]
    ds_read_b64_tr_b16 v[196:197], v11 offset:12288
    ds_read_b64_tr_b16 v[198:199], v11 offset:13312
    v_mfma_f32_32x32x16_bf16 v[144:159], v[212:215], v[20:23], v[144:159]
    ds_read_b64_tr_b16 v[200:201], v12 offset:12288
    v_mfma_f32_32x32x16_bf16 v[160:175], v[216:219], v[20:23], v[160:175]
    ds_read_b64_tr_b16 v[202:203], v12 offset:13312
    ds_read_b64_tr_b16 v[204:205], v13 offset:12288
    v_mfma_f32_32x32x16_bf16 v[176:191], v[220:223], v[20:23], v[176:191]
    ds_read_b64_tr_b16 v[206:207], v13 offset:13312
    s_waitcnt lgkmcnt(8)
    v_mfma_f32_16x16x32_bf16 v[248:251], v[244:247], v[224:227], v[248:251]
    ds_read_b64_tr_b16 v[208:209], v10 offset:16384
    ds_read_b64_tr_b16 v[210:211], v10 offset:17408
    v_mfma_f32_32x32x16_bf16 v[128:143], v[224:227], v[24:27], v[128:143]
    ds_read_b64_tr_b16 v[212:213], v11 offset:16384
    ds_read_b64_tr_b16 v[214:215], v11 offset:17408
    v_mfma_f32_32x32x16_bf16 v[144:159], v[228:231], v[24:27], v[144:159]
    ds_read_b64_tr_b16 v[216:217], v12 offset:16384
    v_mfma_f32_32x32x16_bf16 v[160:175], v[232:235], v[24:27], v[160:175]
    ds_read_b64_tr_b16 v[218:219], v12 offset:17408
    ds_read_b64_tr_b16 v[220:221], v13 offset:16384
    v_mfma_f32_32x32x16_bf16 v[176:191], v[236:239], v[24:27], v[176:191]
    ds_read_b64_tr_b16 v[222:223], v13 offset:17408
    s_waitcnt lgkmcnt(8)
    v_mfma_f32_16x16x32_bf16 v[248:251], v[244:247], v[192:195], v[248:251]
    ds_read_b64_tr_b16 v[224:225], v10 offset:20480
    ds_read_b64_tr_b16 v[226:227], v10 offset:21504
    v_mfma_f32_32x32x16_bf16 v[128:143], v[192:195], v[28:31], v[128:143]
    ds_read_b64_tr_b16 v[228:229], v11 offset:20480
    ds_read_b64_tr_b16 v[230:231], v11 offset:21504
    v_mfma_f32_32x32x16_bf16 v[144:159], v[196:199], v[28:31], v[144:159]
    ds_read_b64_tr_b16 v[232:233], v12 offset:20480
    v_mfma_f32_32x32x16_bf16 v[160:175], v[200:203], v[28:31], v[160:175]
    ds_read_b64_tr_b16 v[234:235], v12 offset:21504
    ds_read_b64_tr_b16 v[236:237], v13 offset:20480
    v_mfma_f32_32x32x16_bf16 v[176:191], v[204:207], v[28:31], v[176:191]
    ds_read_b64_tr_b16 v[238:239], v13 offset:21504
    s_waitcnt lgkmcnt(8)
    v_mfma_f32_16x16x32_bf16 v[248:251], v[244:247], v[208:211], v[248:251]
    ds_read_b64_tr_b16 v[192:193], v10 offset:24576
    ds_read_b64_tr_b16 v[194:195], v10 offset:25600
    v_mfma_f32_32x32x16_bf16 v[128:143], v[208:211], v[32:35], v[128:143]
    ds_read_b64_tr_b16 v[196:197], v11 offset:24576
    ds_read_b64_tr_b16 v[198:199], v11 offset:25600
    v_mfma_f32_32x32x16_bf16 v[144:159], v[212:215], v[32:35], v[144:159]
    ds_read_b64_tr_b16 v[200:201], v12 offset:24576
    v_mfma_f32_32x32x16_bf16 v[160:175], v[216:219], v[32:35], v[160:175]
    ds_read_b64_tr_b16 v[202:203], v12 offset:25600
    ds_read_b64_tr_b16 v[204:205], v13 offset:24576
    v_mfma_f32_32x32x16_bf16 v[176:191], v[220:223], v[32:35], v[176:191]
    ds_read_b64_tr_b16 v[206:207], v13 offset:25600
    s_waitcnt vmcnt(8)
    ds_write_b32 v253, v255 offset:80
    s_waitcnt lgkmcnt(8)
    v_mfma_f32_16x16x32_bf16 v[248:251], v[244:247], v[224:227], v[248:251]
    ds_read_b64_tr_b16 v[208:209], v10 offset:28672
    ds_read_b64_tr_b16 v[210:211], v10 offset:29696
    v_mfma_f32_32x32x16_bf16 v[128:143], v[224:227], v[36:39], v[128:143]
    ds_read_b64_tr_b16 v[212:213], v11 offset:28672
    ds_read_b64_tr_b16 v[214:215], v11 offset:29696
    v_mfma_f32_32x32x16_bf16 v[144:159], v[228:231], v[36:39], v[144:159]
    ds_read_b64_tr_b16 v[216:217], v12 offset:28672
    v_mfma_f32_32x32x16_bf16 v[160:175], v[232:235], v[36:39], v[160:175]
    ds_read_b64_tr_b16 v[218:219], v12 offset:29696
    ds_read_b64_tr_b16 v[220:221], v13 offset:28672
    v_mfma_f32_32x32x16_bf16 v[176:191], v[236:239], v[36:39], v[176:191]
    ds_read_b64_tr_b16 v[222:223], v13 offset:29696
    s_waitcnt lgkmcnt(8)
    v_mfma_f32_16x16x32_bf16 v[248:251], v[244:247], v[192:195], v[248:251]
    v_mfma_f32_32x32x16_bf16 v[128:143], v[192:195], v[40:43], v[128:143]
    v_mfma_f32_32x32x16_bf16 v[144:159], v[196:199], v[40:43], v[144:159]
    s_mov_b32 s61, 320000
LS_5:
    ds_read_b32 v3, v254 offset:80
    s_waitcnt lgkmcnt(0)
    v_cmp_eq_u32 vcc, -1, v3
    s_cbranch_vccz LSD_6
    s_sub_u32 s61, s61, 1
    s_cmp_lg_u32 s61, 0
    s_cbranch_scc1 LS_5
LSD_6:
    v_mfma_f32_32x32x16_bf16 v[160:175], v[200:203], v[40:43], v[160:175]
    ds_read_b64_tr_b16 v[224:225], v10 offset:32768
    ds_read_b64_tr_b16 v[226:227], v10 offset:33792
    ds_read_b64_tr_b16 v[228:229], v11 offset:32768
    ds_read_b64_tr_b16 v[230:231], v11 offset:33792
    v_mfma_f32_32x32x16_bf16 v[176:191], v[204:207], v[40:43], v[176:191]
    ds_read_b64_tr_b16 v[232:233], v12 offset:32768
    ds_read_b64_tr_b16 v[234:235], v12 offset:33792
    ds_read_b64_tr_b16 v[236:237], v13 offset:32768
    ds_read_b64_tr_b16 v[238:239], v13 offset:33792
    s_waitcnt lgkmcnt(8)
    v_mfma_f32_16x16x32_bf16 v[248:251], v[244:247], v[208:211], v[248:251]
    ds_read_b64_tr_b16 v[192:193], v10 offset:36864
    ds_read_b64_tr_b16 v[194:195], v10 offset:37888
    v_mfma_f32_32x32x16_bf16 v[128:143], v[208:211], v[44:47], v[128:143]
    ds_read_b64_tr_b16 v[196:197], v11 offset:36864
    ds_read_b64_tr_b16 v[198:199], v11 offset:37888
    v_mfma_f32_32x32x16_bf16 v[144:159], v[212:215], v[44:47], v[144:159]
    ds_read_b64_tr_b16 v[200:201], v12 offset:36864
    v_mfma_f32_32x32x16_bf16 v[160:175], v[216:219], v[44:47], v[160:175]
    ds_read_b64_tr_b16 v[202:203], v12 offset:37888
    ds_read_b64_tr_b16 v[204:205], v13 offset:36864
    v_mfma_f32_32x32x16_bf16 v[176:191], v[220:223], v[44:47], v[176:191]
    ds_read_b64_tr_b16 v[206:207], v13 offset:37888
    s_waitcnt lgkmcnt(8)
    v_mfma_f32_16x16x32_bf16 v[248:251], v[244:247], v[224:227], v[248:251]
    ds_read_b64_tr_b16 v[208:209], v10 offset:40960
    ds_read_b64_tr_b16 v[210:211], v10 offset:41984
    v_mfma_f32_32x32x16_bf16 v[128:143], v[224:227], v[48:51], v[128:143]
    ds_read_b64_tr_b16 v[212:213], v11 offset:40960
    ds_read_b64_tr_b16 v[214:215], v11 offset:41984
    v_mfma_f32_32x32x16_bf16 v[144:159], v[228:231], v[48:51], v[144:159]
    ds_read_b64_tr_b16 v[216:217], v12 offset:40960
    v_mfma_f32_32x32x16_bf16 v[160:175], v[232:235], v[48:51], v[160:175]
    ds_read_b64_tr_b16 v[218:219], v12 offset:41984
    ds_read_b64_tr_b16 v[220:221], v13 offset:40960
    v_mfma_f32_32x32x16_bf16 v[176:191], v[236:239], v[48:51], v[176:191]
    ds_read_b64_tr_b16 v[222:223], v13 offset:41984
    s_waitcnt lgkmcnt(8)
    v_mfma_f32_16x16x32_bf16 v[248:251], v[244:247], v[192:195], v[248:251]
    ds_read_b64_tr_b16 v[224:225], v10 offset:45056
    ds_read_b64_tr_b16 v[226:227], v10 offset:46080
    v_mfma_f32_32x32x16_bf16 v[128:143], v[192:195], v[52:55], v[128:143]
    ds_read_b64_tr_b16 v[228:229], v11 offset:45056
    ds_read_b64_tr_b16 v[230:231], v11 offset:46080
    v_mfma_f32_32x32x16_bf16 v[144:159], v[196:199], v[52:55], v[144:159]
    ds_read_b64_tr_b16 v[232:233], v12 offset:45056
    v_mfma_f32_32x32x16_bf16 v[160:175], v[200:203], v[52:55], v[160:175]
    ds_read_b64_tr_b16 v[234:235], v12 offset:46080
    ds_read_b64_tr_b16 v[236:237], v13 offset:45056
    v_mfma_f32_32x32x16_bf16 v[176:191], v[204:207], v[52:55], v[176:191]
    ds_read_b64_tr_b16 v[238:239], v13 offset:46080
    s_waitcnt lgkmcnt(8)
    v_mfma_f32_16x16x32_bf16 v[248:251], v[244:247], v[208:211], v[248:251]
    ds_read_b64_tr_b16 v[192:193], v10 offset:49152
    ds_read_b64_tr_b16 v[194:195], v10 offset:50176
    v_mfma_f32_32x32x16_bf16 v[128:143], v[208:211], v[56:59], v[128:143]
    ds_read_b64_tr_b16 v[196:197], v11 offset:49152
    ds_read_b64_tr_b16 v[198:199], v11 offset:50176
    v_mfma_f32_32x32x16_bf16 v[144:159], v[212:215], v[56:59], v[144:159]
    ds_read_b64_tr_b16 v[200:201], v12 offset:49152
    v_mfma_f32_32x32x16_bf16 v[160:175], v[216:219], v[56:59], v[160:175]
    ds_read_b64_tr_b16 v[202:203], v12 offset:50176
    ds_read_b64_tr_b16 v[204:205], v13 offset:49152
    v_mfma_f32_32x32x16_bf16 v[176:191], v[220:223], v[56:59], v[176:191]
    ds_read_b64_tr_b16 v[206:207], v13 offset:50176
    s_waitcnt lgkmcnt(8)
    v_mfma_f32_16x16x32_bf16 v[248:251], v[244:247], v[224:227], v[248:251]
    ds_read_b64_tr_b16 v[208:209], v10 offset:53248
    ds_read_b64_tr_b16 v[210:211], v10 offset:54272
    v_mfma_f32_32x32x16_bf16 v[128:143], v[224:227], v[60:63], v[128:143]
    ds_read_b64_tr_b16 v[212:213], v11 offset:53248
    ds_read_b64_tr_b16 v[214:215], v11 offset:54272
    v_mfma_f32_32x32x16_bf16 v[144:159], v[228:231], v[60:63], v[144:159]
    ds_read_b64_tr_b16 v[216:217], v12 offset:53248
    v_mfma_f32_32x32x16_bf16 v[160:175], v[232:235], v[60:63], v[160:175]
    ds_read_b64_tr_b16 v[218:219], v12 offset:54272
    ds_read_b64_tr_b16 v[220:221], v13 offset:53248
    v_mfma_f32_32x32x16_bf16 v[176:191], v[236:239], v[60:63], v[176:191]
    ds_read_b64_tr_b16 v[222:223], v13 offset:54272
    s_waitcnt lgkmcnt(8)
    v_mfma_f32_16x16x32_bf16 v[248:251], v[244:247], v[192:195], v[248:251]
    ds_read_b64_tr_b16 v[224:225], v10 offset:57344
    ds_read_b64_tr_b16 v[226:227], v10 offset:58368
    v_mfma_f32_32x32x16_bf16 v[128:143], v[192:195], v[64:67], v[128:143]
    ds_read_b64_tr_b16 v[228:229], v11 offset:57344
    ds_read_b64_tr_b16 v[230:231], v11 offset:58368
    v_mfma_f32_32x32x16_bf16 v[144:159], v[196:199], v[64:67], v[144:159]
    ds_read_b64_tr_b16 v[232:233], v12 offset:57344
    v_mfma_f32_32x32x16_bf16 v[160:175], v[200:203], v[64:67], v[160:175]
    ds_read_b64_tr_b16 v[234:235], v12 offset:58368
    ds_read_b64_tr_b16 v[236:237], v13 offset:57344
    v_mfma_f32_32x32x16_bf16 v[176:191], v[204:207], v[64:67], v[176:191]
    ds_read_b64_tr_b16 v[238:239], v13 offset:58368
    s_waitcnt lgkmcnt(8)
    v_mfma_f32_16x16x32_bf16 v[248:251], v[244:247], v[208:211], v[248:251]
    ds_read_b64_tr_b16 v[192:193], v10 offset:61440
    ds_read_b64_tr_b16 v[194:195], v10 offset:62464
    v_mfma_f32_32x32x16_bf16 v[128:143], v[208:211], v[68:71], v[128:143]
    ds_read_b64_tr_b16 v[196:197], v11 offset:61440
    ds_read_b64_tr_b16 v[198:199], v11 offset:62464
    v_mfma_f32_32x32x16_bf16 v[144:159], v[212:215], v[68:71], v[144:159]
    ds_read_b64_tr_b16 v[200:201], v12 offset:61440
    v_mfma_f32_32x32x16_bf16 v[160:175], v[216:219], v[68:71], v[160:175]
    ds_read_b64_tr_b16 v[202:203], v12 offset:62464
    ds_read_b64_tr_b16 v[204:205], v13 offset:61440
    v_mfma_f32_32x32x16_bf16 v[176:191], v[220:223], v[68:71], v[176:191]
    ds_read_b64_tr_b16 v[206:207], v13 offset:62464
    s_waitcnt lgkmcnt(8)
    v_add_u32 v10, 0x10000, v10
    v_add_u32 v11, 0x10000, v11
    v_add_u32 v12, 0x10000, v12
    v_add_u32 v13, 0x10000, v13
    v_mfma_f32_16x16x32_bf16 v[248:251], v[244:247], v[224:227], v[248:251]
    ds_read_b64_tr_b16 v[208:209], v10 offset:0
    ds_read_b64_tr_b16 v[210:211], v10 offset:1024
    v_mfma_f32_32x32x16_bf16 v[128:143], v[224:227], v[72:75], v[128:143]
    ds_read_b64_tr_b16 v[212:213], v11 offset:0
    ds_read_b64_tr_b16 v[214:215], v11 offset:1024
    v_mfma_f32_32x32x16_bf16 v[144:159], v[228:231], v[72:75], v[144:159]
    ds_read_b64_tr_b16 v[216:217], v12 offset:0
    v_mfma_f32_32x32x16_bf16 v[160:175], v[232:235], v[72:75], v[160:175]
    ds_read_b64_tr_b16 v[218:219], v12 offset:1024
    ds_read_b64_tr_b16 v[220:221], v13 offset:0
    v_mfma_f32_32x32x16_bf16 v[176:191], v[236:239], v[72:75], v[176:191]
    ds_read_b64_tr_b16 v[222:223], v13 offset:1024
    s_waitcnt lgkmcnt(8)
    v_mfma_f32_16x16x32_bf16 v[248:251], v[244:247], v[192:195], v[248:251]
    ds_read_b64_tr_b16 v[224:225], v10 offset:4096
    ds_read_b64_tr_b16 v[226:227], v10 offset:5120
    v_mfma_f32_32x32x16_bf16 v[128:143], v[192:195], v[76:79], v[128:143]
    ds_read_b64_tr_b16 v[228:229], v11 offset:4096
    ds_read_b64_tr_b16 v[230:231], v11 offset:5120
    v_mfma_f32_32x32x16_bf16 v[144:159], v[196:199], v[76:79], v[144:159]
    ds_read_b64_tr_b16 v[232:233], v12 offset:4096
    v_mfma_f32_32x32x16_bf16 v[160:175], v[200:203], v[76:79], v[160:175]
    ds_read_b64_tr_b16 v[234:235], v12 offset:5120
    ds_read_b64_tr_b16 v[236:237], v13 offset:4096
    v_mfma_f32_32x32x16_bf16 v[176:191], v[204:207], v[76:79], v[176:191]
    ds_read_b64_tr_b16 v[238:239], v13 offset:5120
    s_waitcnt lgkmcnt(8)
    v_mfma_f32_16x16x32_bf16 v[248:251], v[244:247], v[208:211], v[248:251]
    ds_read_b64_tr_b16 v[192:193], v10 offset:8192
    ds_read_b64_tr_b16 v[194:195], v10 offset:9216
    v_mfma_f32_32x32x16_bf16 v[128:143], v[208:211], v[80:83], v[128:143]
    ds_read_b64_tr_b16 v[196:197], v11 offset:8192
    ds_read_b64_tr_b16 v[198:199], v11 offset:9216
    v_mfma_f32_32x32x16_bf16 v[144:159], v[212:215], v[80:83], v[144:159]
    ds_read_b64_tr_b16 v[200:201], v12 offset:8192
    v_mfma_f32_32x32x16_bf16 v[160:175], v[216:219], v[80:83], v[160:175]
    ds_read_b64_tr_b16 v[202:203], v12 offset:9216
    ds_read_b64_tr_b16 v[204:205], v13 offset:8192
    v_mfma_f32_32x32x16_bf16 v[176:191], v[220:223], v[80:83], v[176:191]
    ds_read_b64_tr_b16 v[206:207], v13 offset:9216
    s_waitcnt vmcnt(0)
    ds_write_b32 v253, v255 offset:96
    s_waitcnt lgkmcnt(8)
    v_mfma_f32_16x16x32_bf16 v[248:251], v[244:247], v[224:227], v[248:251]
    ds_read_b64_tr_b16 v[208:209], v10 offset:12288
    ds_read_b64_tr_b16 v[210:211], v10 offset:13312
    v_mfma_f32_32x32x16_bf16 v[128:143], v[224:227], v[84:87], v[128:143]
    ds_read_b64_tr_b16 v[212:213], v11 offset:12288
    ds_read_b64_tr_b16 v[214:215], v11 offset:13312
    v_mfma_f32_32x32x16_bf16 v[144:159], v[228:231], v[84:87], v[144:159]
    ds_read_b64_tr_b16 v[216:217], v12 offset:12288
    v_mfma_f32_32x32x16_bf16 v[160:175], v[232:235], v[84:87], v[160:175]
    ds_read_b64_tr_b16 v[218:219], v12 offset:13312
    ds_read_b64_tr_b16 v[220:221], v13 offset:12288
    v_mfma_f32_32x32x16_bf16 v[176:191], v[236:239], v[84:87], v[176:191]
    ds_read_b64_tr_b16 v[222:223], v13 offset:13312
    s_waitcnt lgkmcnt(8)
    v_mfma_f32_16x16x32_bf16 v[248:251], v[244:247], v[192:195], v[248:251]
    v_mfma_f32_32x32x16_bf16 v[128:143], v[192:195], v[88:91], v[128:143]
    v_mfma_f32_32x32x16_bf16 v[144:159], v[196:199], v[88:91], v[144:159]
    s_mov_b32 s61, 320000
LS_7:
    ds_read_b32 v3, v254 offset:96
    s_waitcnt lgkmcnt(0)
    v_cmp_eq_u32 vcc, -1, v3
    s_cbranch_vccz LSD_8
    s_sub_u32 s61, s61, 1
    s_cmp_lg_u32 s61, 0
    s_cbranch_scc1 LS_7
LSD_8:
    v_mfma_f32_32x32x16_bf16 v[160:175], v[200:203], v[88:91], v[160:175]
    ds_read_b64_tr_b16 v[224:225], v10 offset:16384
    ds_read_b64_tr_b16 v[226:227], v10 offset:17408
    ds_read_b64_tr_b16 v[228:229], v11 offset:16384
    ds_read_b64_tr_b16 v[230:231], v11 offset:17408
    v_mfma_f32_32x32x16_bf16 v[176:191], v[204:207], v[88:91], v[176:191]
    ds_read_b64_tr_b16 v[232:233], v12 offset:16384
    ds_read_b64_tr_b16 v[234:235], v12 offset:17408
    ds_read_b64_tr_b16 v[236:237], v13 offset:16384
    ds_read_b64_tr_b16 v[238:239], v13 offset:17408
    s_waitcnt lgkmcnt(8)
    v_mfma_f32_16x16x32_bf16 v[248:251], v[244:247], v[208:211], v[248:251]
    ds_read_b64_tr_b16 v[192:193], v10 offset:20480
    ds_read_b64_tr_b16 v[194:195], v10 offset:21504
    v_mfma_f32_32x32x16_bf16 v[128:143], v[208:211], v[92:95], v[128:143]
    ds_read_b64_tr_b16 v[196:197], v11 offset:20480
    ds_read_b64_tr_b16 v[198:199], v11 offset:21504
    v_mfma_f32_32x32x16_bf16 v[144:159], v[212:215], v[92:95], v[144:159]
    ds_read_b64_tr_b16 v[200:201], v12 offset:20480
    v_mfma_f32_32x32x16_bf16 v[160:175], v[216:219], v[92:95], v[160:175]
    ds_read_b64_tr_b16 v[202:203], v12 offset:21504
    ds_read_b64_tr_b16 v[204:205], v13 offset:20480
    v_mfma_f32_32x32x16_bf16 v[176:191], v[220:223], v[92:95], v[176:191]
    ds_read_b64_tr_b16 v[206:207], v13 offset:21504
    s_waitcnt lgkmcnt(8)
    v_mfma_f32_16x16x32_bf16 v[248:251], v[244:247], v[224:227], v[248:251]
    ds_read_b64_tr_b16 v[208:209], v10 offset:24576
    ds_read_b64_tr_b16 v[210:211], v10 offset:25600
    v_mfma_f32_32x32x16_bf16 v[128:143], v[224:227], v[96:99], v[128:143]
    ds_read_b64_tr_b16 v[212:213], v11 offset:24576
    ds_read_b64_tr_b16 v[214:215], v11 offset:25600
    v_mfma_f32_32x32x16_bf16 v[144:159], v[228:231], v[96:99], v[144:159]
    ds_read_b64_tr_b16 v[216:217], v12 offset:24576
    v_mfma_f32_32x32x16_bf16 v[160:175], v[232:235], v[96:99], v[160:175]
    ds_read_b64_tr_b16 v[218:219], v12 offset:25600
    ds_read_b64_tr_b16 v[220:221], v13 offset:24576
    v_mfma_f32_32x32x16_bf16 v[176:191], v[236:239], v[96:99], v[176:191]
    ds_read_b64_tr_b16 v[222:223], v13 offset:25600
    s_waitcnt lgkmcnt(8)
    v_mfma_f32_16x16x32_bf16 v[248:251], v[244:247], v[192:195], v[248:251]
    ds_read_b64_tr_b16 v[224:225], v10 offset:28672
    ds_read_b64_tr_b16 v[226:227], v10 offset:29696
    v_mfma_f32_32x32x16_bf16 v[128:143], v[192:195], v[100:103], v[128:143]
    ds_read_b64_tr_b16 v[228:229], v11 offset:28672
    ds_read_b64_tr_b16 v[230:231], v11 offset:29696
    v_mfma_f32_32x32x16_bf16 v[144:159], v[196:199], v[100:103], v[144:159]
    ds_read_b64_tr_b16 v[232:233], v12 offset:28672
    v_mfma_f32_32x32x16_bf16 v[160:175], v[200:203], v[100:103], v[160:175]
    ds_read_b64_tr_b16 v[234:235], v12 offset:29696
    ds_read_b64_tr_b16 v[236:237], v13 offset:28672
    v_mfma_f32_32x32x16_bf16 v[176:191], v[204:207], v[100:103], v[176:191]
    ds_read_b64_tr_b16 v[238:239], v13 offset:29696
    s_waitcnt lgkmcnt(8)
    v_mfma_f32_16x16x32_bf16 v[248:251], v[244:247], v[208:211], v[248:251]
    ds_read_b64_tr_b16 v[192:193], v10 offset:32768
    ds_read_b64_tr_b16 v[194:195], v10 offset:33792
    v_mfma_f32_32x32x16_bf16 v[128:143], v[208:211], v[104:107], v[128:143]
    ds_read_b64_tr_b16 v[196:197], v11 offset:32768
    ds_read_b64_tr_b16 v[198:199], v11 offset:33792
    v_mfma_f32_32x32x16_bf16 v[144:159], v[212:215], v[104:107], v[144:159]
    ds_read_b64_tr_b16 v[200:201], v12 offset:32768
    v_mfma_f32_32x32x16_bf16 v[160:175], v[216:219], v[104:107], v[160:175]
    ds_read_b64_tr_b16 v[202:203], v12 offset:33792
    ds_read_b64_tr_b16 v[204:205], v13 offset:32768
    v_mfma_f32_32x32x16_bf16 v[176:191], v[220:223], v[104:107], v[176:191]
    ds_read_b64_tr_b16 v[206:207], v13 offset:33792
    s_waitcnt lgkmcnt(8)
    v_mfma_f32_16x16x32_bf16 v[248:251], v[244:247], v[224:227], v[248:251]
    ds_read_b64_tr_b16 v[208:209], v10 offset:36864
    ds_read_b64_tr_b16 v[210:211], v10 offset:37888
    v_mfma_f32_32x32x16_bf16 v[128:143], v[224:227], v[108:111], v[128:143]
    ds_read_b64_tr_b16 v[212:213], v11 offset:36864
    ds_read_b64_tr_b16 v[214:215], v11 offset:37888
    v_mfma_f32_32x32x16_bf16 v[144:159], v[228:231], v[108:111], v[144:159]
    ds_read_b64_tr_b16 v[216:217], v12 offset:36864
    v_mfma_f32_32x32x16_bf16 v[160:175], v[232:235], v[108:111], v[160:175]
    ds_read_b64_tr_b16 v[218:219], v12 offset:37888
    ds_read_b64_tr_b16 v[220:221], v13 offset:36864
    v_mfma_f32_32x32x16_bf16 v[176:191], v[236:239], v[108:111], v[176:191]
    ds_read_b64_tr_b16 v[222:223], v13 offset:37888
    s_waitcnt lgkmcnt(8)
    v_mfma_f32_16x16x32_bf16 v[248:251], v[244:247], v[192:195], v[248:251]
    ds_read_b64_tr_b16 v[224:225], v10 offset:40960
    ds_read_b64_tr_b16 v[226:227], v10 offset:41984
    v_mfma_f32_32x32x16_bf16 v[128:143], v[192:195], v[112:115], v[128:143]
    ds_read_b64_tr_b16 v[228:229], v11 offset:40960
    ds_read_b64_tr_b16 v[230:231], v11 offset:41984
    v_mfma_f32_32x32x16_bf16 v[144:159], v[196:199], v[112:115], v[144:159]
    ds_read_b64_tr_b16 v[232:233], v12 offset:40960
    v_mfma_f32_32x32x16_bf16 v[160:175], v[200:203], v[112:115], v[160:175]
    ds_read_b64_tr_b16 v[234:235], v12 offset:41984
    ds_read_b64_tr_b16 v[236:237], v13 offset:40960
    v_mfma_f32_32x32x16_bf16 v[176:191], v[204:207], v[112:115], v[176:191]
    ds_read_b64_tr_b16 v[238:239], v13 offset:41984
    s_waitcnt lgkmcnt(8)
    v_mfma_f32_16x16x32_bf16 v[248:251], v[244:247], v[208:211], v[248:251]
    ds_read_b64_tr_b16 v[192:193], v10 offset:45056
    ds_read_b64_tr_b16 v[194:195], v10 offset:46080
    v_mfma_f32_32x32x16_bf16 v[128:143], v[208:211], v[116:119], v[128:143]
    ds_read_b64_tr_b16 v[196:197], v11 offset:45056
    ds_read_b64_tr_b16 v[198:199], v11 offset:46080
    v_mfma_f32_32x32x16_bf16 v[144:159], v[212:215], v[116:119], v[144:159]
    ds_read_b64_tr_b16 v[200:201], v12 offset:45056
    v_mfma_f32_32x32x16_bf16 v[160:175], v[216:219], v[116:119], v[160:175]
    ds_read_b64_tr_b16 v[202:203], v12 offset:46080
    ds_read_b64_tr_b16 v[204:205], v13 offset:45056
    v_mfma_f32_32x32x16_bf16 v[176:191], v[220:223], v[116:119], v[176:191]
    ds_read_b64_tr_b16 v[206:207], v13 offset:46080
    s_waitcnt lgkmcnt(8)
    v_mfma_f32_16x16x32_bf16 v[248:251], v[244:247], v[224:227], v[248:251]
    v_mfma_f32_32x32x16_bf16 v[128:143], v[224:227], v[120:123], v[128:143]
    v_mfma_f32_32x32x16_bf16 v[144:159], v[228:231], v[120:123], v[144:159]
    v_mfma_f32_32x32x16_bf16 v[160:175], v[232:235], v[120:123], v[160:175]
    v_mfma_f32_32x32x16_bf16 v[176:191], v[236:239], v[120:123], v[176:191]
    s_waitcnt lgkmcnt(0)
    v_mfma_f32_16x16x32_bf16 v[248:251], v[244:247], v[192:195], v[248:251]
    v_mfma_f32_32x32x16_bf16 v[128:143], v[192:195], v[124:127], v[128:143]
    v_mfma_f32_32x32x16_bf16 v[144:159], v[196:199], v[124:127], v[144:159]
    v_mfma_f32_32x32x16_bf16 v[160:175], v[200:203], v[124:127], v[160:175]
    v_mfma_f32_32x32x16_bf16 v[176:191], v[204:207], v[124:127], v[176:191]
    s_setprio 2
    s_lshl_b32 s53, s49, 8
    s_add_u32 s53, s53, 156672
    v_lshl_add_u32 v5, v0, 2, s53
    v_cvt_pk_bf16_f32 v249, v248, v248
    v_and_b32 v249, 0xffff0000, v249
    v_sub_f32 v248, v248, v249
    v_cvt_pk_bf16_f32 v248, v249, v248
    ds_write_b32 v5, v248
    v_xor_b32 v6, 256, v5
    v_xor_b32 v7, 512, v5
    v_xor_b32 v8, 768, v5
    v_mov_b32 v17, 0
    v_mov_b32 v18, 0
    v_mov_b32 v19, 0
    v_mov_b32 v21, 0
    v_mov_b32 v22, 0
    v_mov_b32 v23, 0
    v_mov_b32 v25, 0
    v_mov_b32 v26, 0
    v_mov_b32 v27, 0
    v_mov_b32 v29, 0
    v_mov_b32 v30, 0
    v_mov_b32 v31, 0
    v_mov_b32 v16, v248
    s_mov_b32 s61, 320000
LS_9:
    ds_read_b32 v20, v6
    ds_read_b32 v24, v7
    ds_read_b32 v28, v8
    s_waitcnt lgkmcnt(0)
    v_cmp_eq_u32 vcc, -1, v20
    v_cmp_eq_u32 s[54:55], -1, v24
    s_or_b64 vcc, vcc, s[54:55]
    v_cmp_eq_u32 s[54:55], -1, v28
    s_or_b64 vcc, vcc, s[54:55]
    s_cbranch_vccz LSD_10
    s_sub_u32 s61, s61, 1
    s_cmp_lg_u32 s61, 0
    s_cbranch_scc1 LS_9
LSD_10:
    v_mfma_f32_32x32x16_bf16 v[128:143], v[16:19], v[240:243], v[128:143]
    v_mfma_f32_32x32x16_bf16 v[144:159], v[20:23], v[240:243], v[144:159]
    v_mfma_f32_32x32x16_bf16 v[160:175], v[24:27], v[240:243], v[160:175]
    v_mfma_f32_32x32x16_bf16 v[176:191], v[28:31], v[240:243], v[176:191]
    s_mul_i32 s53, s52, 147456
    s_lshl_b32 s54, s51, 13
    s_add_u32 s53, s53, s54
    s_add_u32 s53, s53, 6291456
    s_lshl_b32 s54, s49, 11
    s_add_u32 s53, s53, s54
    v_lshl_add_u32 v64, v0, 4, s53
    v_xor_b32 v65, 2048, v64
    v_xor_b32 v66, 4096, v64
    v_xor_b32 v67, 6144, v64
    v_cvt_pk_bf16_f32 v32, v128, v129
    v_pk_max_i16 v32, v32, 0
    v_cvt_pk_bf16_f32 v33, v130, v131
    v_pk_max_i16 v33, v33, 0
    v_cvt_pk_bf16_f32 v34, v132, v133
    v_pk_max_i16 v34, v34, 0
    v_cvt_pk_bf16_f32 v35, v134, v135
    v_pk_max_i16 v35, v35, 0
    v_cvt_pk_bf16_f32 v36, v136, v137
    v_pk_max_i16 v36, v36, 0
    v_cvt_pk_bf16_f32 v37, v138, v139
    v_pk_max_i16 v37, v37, 0
    v_cvt_pk_bf16_f32 v38, v140, v141
    v_pk_max_i16 v38, v38, 0
    v_cvt_pk_bf16_f32 v39, v142, v143
    v_pk_max_i16 v39, v39, 0
    v_cvt_pk_bf16_f32 v40, v144, v145
    v_pk_max_i16 v40, v40, 0
    v_cvt_pk_bf16_f32 v41, v146, v147
    v_pk_max_i16 v41, v41, 0
    v_cvt_pk_bf16_f32 v42, v148, v149
    v_pk_max_i16 v42, v42, 0
    v_cvt_pk_bf16_f32 v43, v150, v151
    v_pk_max_i16 v43, v43, 0
    v_cvt_pk_bf16_f32 v44, v152, v153
    v_pk_max_i16 v44, v44, 0
    v_cvt_pk_bf16_f32 v45, v154, v155
    v_pk_max_i16 v45, v45, 0
    v_cvt_pk_bf16_f32 v46, v156, v157
    v_pk_max_i16 v46, v46, 0
    v_cvt_pk_bf16_f32 v47, v158, v159
    v_pk_max_i16 v47, v47, 0
    v_cvt_pk_bf16_f32 v48, v160, v161
    v_pk_max_i16 v48, v48, 0
    v_cvt_pk_bf16_f32 v49, v162, v163
    v_pk_max_i16 v49, v49, 0
    v_cvt_pk_bf16_f32 v50, v164, v165
    v_pk_max_i16 v50, v50, 0
    v_cvt_pk_bf16_f32 v51, v166, v167
    v_pk_max_i16 v51, v51, 0
    v_cvt_pk_bf16_f32 v52, v168, v169
    v_pk_max_i16 v52, v52, 0
    v_cvt_pk_bf16_f32 v53, v170, v171
    v_pk_max_i16 v53, v53, 0
    v_cvt_pk_bf16_f32 v54, v172, v173
    v_pk_max_i16 v54, v54, 0
    v_cvt_pk_bf16_f32 v55, v174, v175
    v_pk_max_i16 v55, v55, 0
    v_cvt_pk_bf16_f32 v56, v176, v177
    v_pk_max_i16 v56, v56, 0
    v_cvt_pk_bf16_f32 v57, v178, v179
    v_pk_max_i16 v57, v57, 0
    v_cvt_pk_bf16_f32 v58, v180, v181
    v_pk_max_i16 v58, v58, 0
    v_cvt_pk_bf16_f32 v59, v182, v183
    v_pk_max_i16 v59, v59, 0
    v_cvt_pk_bf16_f32 v60, v184, v185
    v_pk_max_i16 v60, v60, 0
    v_cvt_pk_bf16_f32 v61, v186, v187
    v_pk_max_i16 v61, v61, 0
    v_cvt_pk_bf16_f32 v62, v188, v189
    v_pk_max_i16 v62, v62, 0
    v_cvt_pk_bf16_f32 v63, v190, v191
    v_pk_max_i16 v63, v63, 0
    s_mul_i32 s10, s49, 12288
    s_add_u32 m0, s10, 0
    s_mul_i32 s56, s41, 57344
    s_add_u32 s56, s56, 0
    buffer_load_dwordx4 v14, s[32:35], s56 offen lds
    s_lshl_b32 s4, s52, 4
    s_add_u32 s4, s4, s51
    s_lshl_b32 s4, s4, 7
    s_add_u32 s4, s4, 18939904
    s_and_b32 s53, s2, 3
    s_lshl_b32 s53, s53, 3
    s_and_b32 s54, s2, 4
    s_add_u32 s53, s53, s54
    s_bfe_u32 s54, s2, 0x20003
    s_add_u32 s50, s53, s54
    s_lshr_b32 s51, s2, 5
    s_mov_b32 s28, s8
    s_mov_b32 s29, s9
    s_mov_b32 s30, 401408
    s_mov_b32 s31, 0x00020000
    s_lshr_b32 s6, s49, 1
    s_and_b32 s7, s49, 1
    v_lshlrev_b32 v250, 4, v0
    buffer_load_dwordx4 v15, s[32:35], s56 offen offset:1024 lds
    s_mul_i32 s57, s49, 28672
    s_lshl_b32 s53, s50, 1
    s_add_u32 s53, s53, s6
    s_xor_b32 s54, s53, 1
    s_mul_i32 s53, s53, 147456
    s_mul_i32 s54, s54, 147456
    s_add_u32 s55, s57, 6291456
    s_add_u32 s54, s54, s55
    v_add_u32 v11, s54, v250
    s_add_u32 s54, s53, s55
    v_add_u32 v10, s54, v250
    v_add_u32 v248, s10, v250
    s_xor_b32 s53, s49, 1
    s_mul_i32 s54, s53, 12288
    v_add_u32 v249, s54, v250
    s_lshl_b32 s53, s53, 2
    s_add_u32 s53, s53, 158768
    s_add_u32 m0, s10, 2048
    s_mul_i32 s56, s41, 57344
    s_add_u32 s56, s56, 14336
    buffer_load_dwordx4 v14, s[32:35], s56 offen lds
    s_lshl_b32 s54, s6, 3
    s_add_u32 s54, s54, 158864
    v_and_b32 v3, 1, v0
    v_lshl_add_u32 v7, v3, 2, s54
    v_writelane_b32 v7, s53, 2
    v_bfe_u32 v3, v0, 2, 2
    v_lshl_add_u32 v4, v2, 2, v3
    v_lshlrev_b32 v4, 7, v4
    v_lshrrev_b32 v3, 1, v3
    v_xor_b32 v3, s7, v3
    v_lshl_add_u32 v4, v3, 6, v4
    v_and_b32 v3, 1, v0
    v_lshl_add_u32 v4, v3, 5, v4
    v_bfe_u32 v3, v0, 4, 1
    v_lshl_add_u32 v4, v3, 4, v4
    v_bfe_u32 v3, v0, 1, 1
    v_lshl_add_u32 v4, v3, 3, v4
    v_add_u32 v12, s47, v4
    buffer_load_dwordx4 v15, s[32:35], s56 offen offset:1024 lds
    v_xor_b32 v8, 64, v12
    v_add_u32 v244, s10, v4
    v_xor_b32 v245, 64, v244
    s_mul_i32 s53, s7, 29696
    s_add_u32 s53, s53, 49152
    s_mul_i32 s5, s6, 14336
    s_add_u32 s5, s5, s53
    s_mul_i32 s53, s7, 200704
    s_mul_i32 s54, s6, 100352
    s_add_u32 s53, s53, s54
    s_mul_i32 s54, s49, 401408
    s_sub_u32 s53, s53, s54
    v_add_u32 v246, s53, v14
    v_add_u32 v251, s47, v250
    s_xor_b32 s53, s49, 2
    s_lshl_b32 s53, s53, 13
    s_add_u32 s53, s53, 114688
    s_add_u32 m0, s10, 4096
    s_mul_i32 s56, s41, 57344
    s_add_u32 s56, s56, 28672
    buffer_load_dwordx4 v14, s[32:35], s56 offen lds
    v_add_u32 v252, s53, v250
    s_xor_b32 s53, s49, 3
    s_lshl_b32 s53, s53, 13
    s_add_u32 s53, s53, 114688
    v_add_u32 v13, s53, v250
    s_mul_i32 s53, s49, 7
    s_lshr_b32 s53, s53, 1
    v_and_b32 v4, 3, v0
    v_and_b32 v5, 16, v0
    v_add3_u32 v4, v4, v5, s53
    s_lshl_b32 s53, s50, 12
    s_add_u32 s53, s53, 18939904
    v_lshl_add_u32 v20, v4, 7, s53
    s_and_b32 s53, s50, 2
    s_add_u32 s53, s53, s7
    s_lshl_b32 s53, s53, 10
    s_add_u32 s54, s53, 18903040
    v_and_b32 v4, 7, v0
    buffer_load_dwordx4 v15, s[32:35], s56 offen offset:1024 lds
    v_lshl_add_u32 v254, v4, 7, s54
    v_lshlrev_b32 v4, 7, v1
    v_add_u32 v4, 18903040, v4
    s_cmp_eq_u32 s2, 0
    s_mov_b32 vcc_lo, 0
    s_cselect_b32 vcc_hi, -1, 0
    v_cndmask_b32 v254, v254, v4, vcc
    s_lshl_b32 s53, s6, 5
    s_lshl_b32 s54, s50, 6
    s_add_u32 s53, s53, s54
    v_add_u32 v9, s53, v1
    v_lshlrev_b32 v247, 4, v9
    v_add_u32 v247, 19202048, v247
    v_mul_u32_u24 v9, 896, v9
    v_lshl_add_u32 v9, v2, 5, v9
    s_lshl_b32 s53, s7, 6
    s_lshl_b32 s54, s51, 7
    s_add_u32 s53, s53, s54
    v_add_u32 v9, s53, v9
    v_lshl_add_u32 v70, v0, 3, s4
    v_mov_b32 v68, s62
    v_mov_b32 v69, s63
    s_setprio 0
    s_waitcnt vmcnt(4)
    s_add_u32 m0, s10, 6144
    s_mul_i32 s56, s41, 57344
    s_add_u32 s56, s56, 43008
    buffer_load_dwordx4 v14, s[32:35], s56 offen lds
    buffer_load_dwordx4 v15, s[32:35], s56 offen offset:1024 lds
    s_waitcnt vmcnt(4)
    s_add_u32 m0, s10, 8192
    s_mul_i32 s56, s42, 57344
    s_add_u32 s56, s56, 0
    buffer_load_dwordx4 v14, s[32:35], s56 offen lds
    buffer_load_dwordx4 v15, s[32:35], s56 offen offset:1024 lds
    s_setprio 2
    s_mov_b32 s61, 320000
LS_11:
    ds_read_b32 v3, v253 offset:112
    s_waitcnt lgkmcnt(0)
    v_cmp_eq_u32 vcc, -1, v3
    s_cbranch_vccz LSD_12
    s_sleep 2
    s_sub_u32 s61, s61, 1
    s_cmp_lg_u32 s61, 0
    s_cbranch_scc1 LS_11
LSD_12:
    s_setprio 0
    buffer_store_dwordx4 v[32:35], v64, s[36:39], 0 offen offset:0 sc1
    buffer_store_dwordx4 v[36:39], v64, s[36:39], 0 offen offset:1024 sc1
    buffer_store_dwordx4 v[40:43], v65, s[36:39], 0 offen offset:0 sc1
    buffer_store_dwordx4 v[44:47], v65, s[36:39], 0 offen offset:1024 sc1
    s_waitcnt vmcnt(63)
    ds_read_b64_tr_b16 v[88:89], v12 offset:0
    ds_read_b64_tr_b16 v[90:91], v12 offset:1024
    ds_read_b64_tr_b16 v[92:93], v8 offset:0
    ds_read_b64_tr_b16 v[94:95], v8 offset:1024
    s_waitcnt vmcnt(63)
    ds_read_b64_tr_b16 v[104:105], v12 offset:2048
    ds_read_b64_tr_b16 v[106:107], v12 offset:3072
    ds_read_b64_tr_b16 v[108:109], v8 offset:2048
    ds_read_b64_tr_b16 v[110:111], v8 offset:3072
    s_waitcnt vmcnt(4)
    s_add_u32 m0, s10, 10240
    s_mul_i32 s56, s42, 57344
    s_add_u32 s56, s56, 14336
    buffer_load_dwordx4 v14, s[32:35], s56 offen lds
    buffer_load_dwordx4 v15, s[32:35], s56 offen offset:1024 lds
    buffer_store_dwordx4 v[48:51], v66, s[36:39], 0 offen offset:0 sc1
    buffer_store_dwordx4 v[52:55], v66, s[36:39], 0 offen offset:1024 sc1
    buffer_store_dwordx4 v[56:59], v67, s[36:39], 0 offen offset:0 sc1
    buffer_store_dwordx4 v[60:63], v67, s[36:39], 0 offen offset:1024 sc1
    s_waitcnt lgkmcnt(0)
    s_waitcnt vmcnt(4)
    s_add_u32 m0, s47, 0
    s_mul_i32 s56, s42, 57344
    s_add_u32 s56, s56, 28672
    buffer_load_dwordx4 v14, s[32:35], s56 offen lds
    buffer_load_dwordx4 v15, s[32:35], s56 offen offset:1024 lds
    s_waitcnt vmcnt(4)
    s_add_u32 m0, s47, 2048
    s_mul_i32 s56, s42, 57344
    s_add_u32 s56, s56, 43008
    buffer_load_dwordx4 v14, s[32:35], s56 offen lds
    buffer_load_dwordx4 v15, s[32:35], s56 offen offset:1024 lds
    s_waitcnt vmcnt(4)
    s_mov_b64 exec, 0xffff
    buffer_store_dwordx2 v[68:69], v70, s[36:39], 0 offen sc1
    s_mov_b64 exec, -1
    s_waitcnt vmcnt(63)
    ds_read_b64_tr_b16 v[120:121], v12 offset:4096
    ds_read_b64_tr_b16 v[122:123], v12 offset:5120
    ds_read_b64_tr_b16 v[124:125], v8 offset:4096
    ds_read_b64_tr_b16 v[126:127], v8 offset:5120
    s_waitcnt vmcnt(63)
    ds_read_b64_tr_b16 v[136:137], v12 offset:6144
    ds_read_b64_tr_b16 v[138:139], v12 offset:7168
    ds_read_b64_tr_b16 v[140:141], v8 offset:6144
    ds_read_b64_tr_b16 v[142:143], v8 offset:7168
    s_waitcnt vmcnt(4)
    s_add_u32 m0, s5, 0
    s_mov_b32 s56, 0
    buffer_load_dwordx4 v246, s[28:31], s56 offen lds
    s_waitcnt lgkmcnt(0)
    s_waitcnt vmcnt(4)
    s_add_u32 m0, s47, 4096
    s_mul_i32 s56, s43, 57344
    s_add_u32 s56, s56, 0
    buffer_load_dwordx4 v14, s[32:35], s56 offen lds
    buffer_load_dwordx4 v15, s[32:35], s56 offen offset:1024 lds
    s_waitcnt vmcnt(4)
    s_add_u32 m0, s47, 6144
    s_mul_i32 s56, s43, 57344
    s_add_u32 s56, s56, 14336
    buffer_load_dwordx4 v14, s[32:35], s56 offen lds
    buffer_load_dwordx4 v15, s[32:35], s56 offen offset:1024 lds
    s_waitcnt vmcnt(28)
    ds_read_b64_tr_b16 v[152:153], v244 offset:0
    ds_read_b64_tr_b16 v[154:155], v244 offset:1024
    ds_read_b64_tr_b16 v[156:157], v245 offset:0
    ds_read_b64_tr_b16 v[158:159], v245 offset:1024
    s_waitcnt vmcnt(26)
    ds_read_b64_tr_b16 v[168:169], v244 offset:2048
    ds_read_b64_tr_b16 v[170:171], v244 offset:3072
    ds_read_b64_tr_b16 v[172:173], v245 offset:2048
    ds_read_b64_tr_b16 v[174:175], v245 offset:3072
    s_waitcnt vmcnt(4)
    s_add_u32 m0, s5, 1024
    s_mov_b32 s56, 7168
    buffer_load_dwordx4 v246, s[28:31], s56 offen lds
    s_waitcnt lgkmcnt(0)
    s_waitcnt vmcnt(4)
    s_add_u32 m0, s10, 0
    s_mul_i32 s56, s43, 57344
    s_add_u32 s56, s56, 28672
    buffer_load_dwordx4 v14, s[32:35], s56 offen lds
    buffer_load_dwordx4 v15, s[32:35], s56 offen offset:1024 lds
    s_waitcnt vmcnt(4)
    s_add_u32 m0, s10, 2048
    s_mul_i32 s56, s43, 57344
    s_add_u32 s56, s56, 43008
    buffer_load_dwordx4 v14, s[32:35], s56 offen lds
    buffer_load_dwordx4 v15, s[32:35], s56 offen offset:1024 lds
    s_waitcnt vmcnt(29)
    ds_read_b64_tr_b16 v[184:185], v244 offset:4096
    ds_read_b64_tr_b16 v[186:187], v244 offset:5120
    ds_read_b64_tr_b16 v[188:189], v245 offset:4096
    ds_read_b64_tr_b16 v[190:191], v245 offset:5120
    s_waitcnt vmcnt(27)
    ds_read_b64_tr_b16 v[200:201], v244 offset:6144
    ds_read_b64_tr_b16 v[202:203], v244 offset:7168
    ds_read_b64_tr_b16 v[204:205], v245 offset:6144
    ds_read_b64_tr_b16 v[206:207], v245 offset:7168
    s_waitcnt vmcnt(4)
    s_add_u32 m0, s5, 2048
    s_mov_b32 s56, 14336
    buffer_load_dwordx4 v246, s[28:31], s56 offen lds
    s_waitcnt lgkmcnt(0)
    s_waitcnt vmcnt(4)
    s_add_u32 m0, s10, 4096
    s_mul_i32 s56, s44, 57344
    s_add_u32 s56, s56, 0
    buffer_load_dwordx4 v14, s[32:35], s56 offen lds
    buffer_load_dwordx4 v15, s[32:35], s56 offen offset:1024 lds
    buffer_load_dwordx2 v[24:25], v20, s[36:39], 0 offen sc1
    s_waitcnt vmcnt(29)
    ds_read_b64_tr_b16 v[216:217], v244 offset:8192
    ds_read_b64_tr_b16 v[218:219], v244 offset:9216
    ds_read_b64_tr_b16 v[220:221], v245 offset:8192
    ds_read_b64_tr_b16 v[222:223], v245 offset:9216
    s_waitcnt vmcnt(23)
    ds_read_b64_tr_b16 v[232:233], v244 offset:10240
    ds_read_b64_tr_b16 v[234:235], v244 offset:11264
    ds_read_b64_tr_b16 v[236:237], v245 offset:10240
    ds_read_b64_tr_b16 v[238:239], v245 offset:11264
    s_waitcnt vmcnt(4)
    s_add_u32 m0, s5, 3072
    s_mov_b32 s56, 21504
    buffer_load_dwordx4 v246, s[28:31], s56 offen lds
    s_waitcnt lgkmcnt(0)
    s_setprio 2
    s_mov_b32 s61, 40000
    s_waitcnt vmcnt(1)
    v_cmp_ne_u64 vcc, s[62:63], v[24:25]
    s_cbranch_vccz PLD_14
PL_13:
    buffer_load_dwordx2 v[24:25], v20, s[36:39], 0 offen sc1
    s_waitcnt vmcnt(0)
    v_cmp_ne_u64 vcc, s[62:63], v[24:25]
    s_cbranch_vccz PLD_14
    s_sleep 2
    s_sub_u32 s61, s61, 1
    s_cmp_lg_u32 s61, 0
    s_cbranch_scc1 PL_13
PLD_14:
    s_setprio 0
    s_waitcnt vmcnt(4)
    s_mul_i32 s56, s40, 4096
    buffer_load_dwordx4 v[80:83], v10, s[36:39], s56 offen offset:0 sc1
    buffer_load_dwordx4 v[84:87], v11, s[36:39], s56 offen offset:0 sc1
    s_waitcnt vmcnt(4)
    s_mul_i32 s56, s40, 4096
    buffer_load_dwordx4 v[96:99], v10, s[36:39], s56 offen offset:1024 sc1
    buffer_load_dwordx4 v[100:103], v11, s[36:39], s56 offen offset:1024 sc1
    s_waitcnt vmcnt(4)
    s_mul_i32 s56, s40, 4096
    buffer_load_dwordx4 v[112:115], v10, s[36:39], s56 offen offset:2048 sc1
    buffer_load_dwordx4 v[116:119], v11, s[36:39], s56 offen offset:2048 sc1
    s_waitcnt vmcnt(4) lgkmcnt(0)
    v_mfma_f32_32x32x16_bf16 v[48:63], v[88:91], v[84:87], 0
    s_waitcnt vmcnt(4)
    s_mul_i32 s56, s40, 4096
    buffer_load_dwordx4 v[128:131], v10, s[36:39], s56 offen offset:3072 sc1
    v_mfma_f32_32x32x16_bf16 v[64:79], v[92:95], v[84:87], 0
    buffer_load_dwordx4 v[132:135], v11, s[36:39], s56 offen offset:3072 sc1
    s_waitcnt vmcnt(4)
    v_mfma_f32_32x32x16_bf16 v[16:31], v[88:91], v[80:83], 0
    s_mul_i32 s56, s41, 4096
    buffer_load_dwordx4 v[144:147], v10, s[36:39], s56 offen offset:0 sc1
    v_mfma_f32_32x32x16_bf16 v[32:47], v[92:95], v[80:83], 0
    buffer_load_dwordx4 v[148:151], v11, s[36:39], s56 offen offset:0 sc1
    s_waitcnt vmcnt(4)
    s_add_u32 m0, s5, 4096
    s_mov_b32 s56, 28672
    buffer_load_dwordx4 v246, s[28:31], s56 offen lds
    s_waitcnt vmcnt(7) lgkmcnt(0)
    v_mfma_f32_32x32x16_bf16 v[48:63], v[104:107], v[100:103], v[48:63]
    s_waitcnt vmcnt(4)
    s_mul_i32 s56, s41, 4096
    buffer_load_dwordx4 v[160:163], v10, s[36:39], s56 offen offset:1024 sc1
    buffer_load_dwordx4 v[164:167], v11, s[36:39], s56 offen offset:1024 sc1
    v_mfma_f32_32x32x16_bf16 v[64:79], v[108:111], v[100:103], v[64:79]
    s_waitcnt vmcnt(4)
    s_mul_i32 s56, s41, 4096
    buffer_load_dwordx4 v[176:179], v10, s[36:39], s56 offen offset:2048 sc1
    v_mfma_f32_32x32x16_bf16 v[16:31], v[104:107], v[96:99], v[16:31]
    buffer_load_dwordx4 v[180:183], v11, s[36:39], s56 offen offset:2048 sc1
    s_waitcnt vmcnt(4)
    s_add_u32 m0, s5, 5120
    s_mov_b32 s56, 35840
    buffer_load_dwordx4 v246, s[28:31], s56 offen lds
    s_waitcnt vmcnt(34)
    ds_read_b64_tr_b16 v[88:89], v12 offset:0
    v_mfma_f32_32x32x16_bf16 v[32:47], v[108:111], v[96:99], v[32:47]
    ds_read_b64_tr_b16 v[90:91], v12 offset:1024
    ds_read_b64_tr_b16 v[92:93], v8 offset:0
    ds_read_b64_tr_b16 v[94:95], v8 offset:1024
    s_waitcnt vmcnt(10) lgkmcnt(0)
    v_mfma_f32_32x32x16_bf16 v[48:63], v[120:123], v[116:119], v[48:63]
    s_waitcnt vmcnt(4)
    s_add_u32 m0, s47, 0
    s_mul_i32 s56, s44, 57344
    s_add_u32 s56, s56, 14336
    buffer_load_dwordx4 v14, s[32:35], s56 offen lds
    buffer_load_dwordx4 v15, s[32:35], s56 offen offset:1024 lds
    s_waitcnt vmcnt(4)
    s_mul_i32 s56, s41, 4096
    v_mfma_f32_32x32x16_bf16 v[64:79], v[124:127], v[116:119], v[64:79]
    buffer_load_dwordx4 v[192:195], v10, s[36:39], s56 offen offset:3072 sc1
    buffer_load_dwordx4 v[196:199], v11, s[36:39], s56 offen offset:3072 sc1
    s_waitcnt vmcnt(4)
    s_mul_i32 s56, s42, 4096
    v_mfma_f32_32x32x16_bf16 v[16:31], v[120:123], v[112:115], v[16:31]
    buffer_load_dwordx4 v[208:211], v10, s[36:39], s56 offen offset:0 sc1
    buffer_load_dwordx4 v[212:215], v11, s[36:39], s56 offen offset:0 sc1
    s_waitcnt vmcnt(4)
    s_add_u32 m0, s5, 6144
    s_mov_b32 s56, 43008
    buffer_load_dwordx4 v246, s[28:31], s56 offen lds
    s_waitcnt vmcnt(39)
    v_mfma_f32_32x32x16_bf16 v[32:47], v[124:127], v[112:115], v[32:47]
    ds_read_b64_tr_b16 v[104:105], v12 offset:2048
    ds_read_b64_tr_b16 v[106:107], v12 offset:3072
    ds_read_b64_tr_b16 v[108:109], v8 offset:2048
    ds_read_b64_tr_b16 v[110:111], v8 offset:3072
    s_waitcnt vmcnt(15) lgkmcnt(0)
    v_mfma_f32_32x32x16_bf16 v[48:63], v[136:139], v[132:135], v[48:63]
    s_waitcnt vmcnt(4)
    s_add_u32 m0, s47, 2048
    s_mul_i32 s56, s44, 57344
    s_add_u32 s56, s56, 28672
    buffer_load_dwordx4 v14, s[32:35], s56 offen lds
    buffer_load_dwordx4 v15, s[32:35], s56 offen offset:1024 lds
    s_waitcnt vmcnt(4)
    s_mul_i32 s56, s42, 4096
    v_mfma_f32_32x32x16_bf16 v[64:79], v[140:143], v[132:135], v[64:79]
    buffer_load_dwordx4 v[224:227], v10, s[36:39], s56 offen offset:1024 sc1
    buffer_load_dwordx4 v[228:231], v11, s[36:39], s56 offen offset:1024 sc1
    s_waitcnt vmcnt(4)
    s_mul_i32 s56, s42, 4096
    v_mfma_f32_32x32x16_bf16 v[16:31], v[136:139], v[128:131], v[16:31]
    buffer_load_dwordx4 v[80:83], v10, s[36:39], s56 offen offset:2048 sc1
    buffer_load_dwordx4 v[84:87], v11, s[36:39], s56 offen offset:2048 sc1
    s_waitcnt vmcnt(4)
    s_add_u32 m0, s5, 7168
    s_mov_b32 s56, 50176
    buffer_load_dwordx4 v246, s[28:31], s56 offen lds
    s_waitcnt vmcnt(42)
    v_mfma_f32_32x32x16_bf16 v[32:47], v[140:143], v[128:131], v[32:47]
    ds_read_b64_tr_b16 v[120:121], v12 offset:4096
    ds_read_b64_tr_b16 v[122:123], v12 offset:5120
    ds_read_b64_tr_b16 v[124:125], v8 offset:4096
    ds_read_b64_tr_b16 v[126:127], v8 offset:5120
    s_waitcnt vmcnt(20) lgkmcnt(0)
    v_mfma_f32_32x32x16_bf16 v[48:63], v[152:155], v[148:151], v[48:63]
    s_waitcnt vmcnt(4)
    s_add_u32 m0, s47, 4096
    s_mul_i32 s56, s44, 57344
    s_add_u32 s56, s56, 43008
    buffer_load_dwordx4 v14, s[32:35], s56 offen lds
    buffer_load_dwordx4 v15, s[32:35], s56 offen offset:1024 lds
    s_waitcnt vmcnt(4)
    s_mul_i32 s56, s42, 4096
    v_mfma_f32_32x32x16_bf16 v[64:79], v[156:159], v[148:151], v[64:79]
    buffer_load_dwordx4 v[96:99], v10, s[36:39], s56 offen offset:3072 sc1
    buffer_load_dwordx4 v[100:103], v11, s[36:39], s56 offen offset:3072 sc1
    s_waitcnt vmcnt(4)
    s_mul_i32 s56, s43, 4096
    v_mfma_f32_32x32x16_bf16 v[16:31], v[152:155], v[144:147], v[16:31]
    buffer_load_dwordx4 v[112:115], v10, s[36:39], s56 offen offset:0 sc1
    buffer_load_dwordx4 v[116:119], v11, s[36:39], s56 offen offset:0 sc1
    s_waitcnt vmcnt(4)
    s_add_u32 m0, s5, 8192
    s_mov_b32 s56, 57344
    buffer_load_dwordx4 v246, s[28:31], s56 offen lds
    s_waitcnt vmcnt(47)
    v_mfma_f32_32x32x16_bf16 v[32:47], v[156:159], v[144:147], v[32:47]
    ds_read_b64_tr_b16 v[136:137], v12 offset:6144
    ds_read_b64_tr_b16 v[138:139], v12 offset:7168
    ds_read_b64_tr_b16 v[140:141], v8 offset:6144
    ds_read_b64_tr_b16 v[142:143], v8 offset:7168
    s_waitcnt vmcnt(24) lgkmcnt(0)
    v_mfma_f32_32x32x16_bf16 v[48:63], v[168:171], v[164:167], v[48:63]
    s_waitcnt vmcnt(4)
    s_add_u32 m0, s47, 6144
    s_mul_i32 s56, s45, 57344
    s_add_u32 s56, s56, 0
    buffer_load_dwordx4 v14, s[32:35], s56 offen lds
    buffer_load_dwordx4 v15, s[32:35], s56 offen offset:1024 lds
    s_waitcnt vmcnt(4)
    s_mul_i32 s56, s43, 4096
    v_mfma_f32_32x32x16_bf16 v[64:79], v[172:175], v[164:167], v[64:79]
    buffer_load_dwordx4 v[128:131], v10, s[36:39], s56 offen offset:1024 sc1
    buffer_load_dwordx4 v[132:135], v11, s[36:39], s56 offen offset:1024 sc1
    s_waitcnt vmcnt(4)
    s_mul_i32 s56, s43, 4096
    v_mfma_f32_32x32x16_bf16 v[16:31], v[168:171], v[160:163], v[16:31]
    buffer_load_dwordx4 v[144:147], v10, s[36:39], s56 offen offset:2048 sc1
    buffer_load_dwordx4 v[148:151], v11, s[36:39], s56 offen offset:2048 sc1
    s_waitcnt vmcnt(4)
    s_add_u32 m0, s5, 9216
    s_mov_b32 s56, 64512
    buffer_load_dwordx4 v246, s[28:31], s56 offen lds
    s_waitcnt vmcnt(51)
    v_mfma_f32_32x32x16_bf16 v[32:47], v[172:175], v[160:163], v[32:47]
    ds_read_b64_tr_b16 v[152:153], v244 offset:0
    ds_read_b64_tr_b16 v[154:155], v244 offset:1024
    ds_read_b64_tr_b16 v[156:157], v245 offset:0
    ds_read_b64_tr_b16 v[158:159], v245 offset:1024
    s_waitcnt vmcnt(29) lgkmcnt(0)
    v_mfma_f32_32x32x16_bf16 v[48:63], v[184:187], v[180:183], v[48:63]
    s_waitcnt vmcnt(4)
    s_mul_i32 s56, s43, 4096
    buffer_load_dwordx4 v[160:163], v10, s[36:39], s56 offen offset:3072 sc1
    v_mfma_f32_32x32x16_bf16 v[64:79], v[188:191], v[180:183], v[64:79]
    buffer_load_dwordx4 v[164:167], v11, s[36:39], s56 offen offset:3072 sc1
    s_waitcnt vmcnt(4)
    s_add_u32 m0, s5, 10240
    s_mov_b32 s56, 71680
    buffer_load_dwordx4 v246, s[28:31], s56 offen lds
    v_mfma_f32_32x32x16_bf16 v[16:31], v[184:187], v[176:179], v[16:31]
    s_waitcnt vmcnt(52)
    ds_read_b64_tr_b16 v[168:169], v244 offset:2048
    ds_read_b64_tr_b16 v[170:171], v244 offset:3072
    v_mfma_f32_32x32x16_bf16 v[32:47], v[188:191], v[176:179], v[32:47]
    ds_read_b64_tr_b16 v[172:173], v245 offset:2048
    ds_read_b64_tr_b16 v[174:175], v245 offset:3072
    s_waitcnt vmcnt(27) lgkmcnt(0)
    v_mfma_f32_32x32x16_bf16 v[48:63], v[200:203], v[196:199], v[48:63]
    s_waitcnt vmcnt(4)
    s_mul_i32 s56, s44, 4096
    buffer_load_dwordx4 v[176:179], v10, s[36:39], s56 offen offset:0 sc1
    v_mfma_f32_32x32x16_bf16 v[64:79], v[204:207], v[196:199], v[64:79]
    buffer_load_dwordx4 v[180:183], v11, s[36:39], s56 offen offset:0 sc1
    s_waitcnt vmcnt(4)
    s_add_u32 m0, s5, 11264
    s_mov_b32 s56, 78848
    buffer_load_dwordx4 v246, s[28:31], s56 offen lds
    v_mfma_f32_32x32x16_bf16 v[16:31], v[200:203], v[192:195], v[16:31]
    s_waitcnt vmcnt(52)
    ds_read_b64_tr_b16 v[184:185], v244 offset:4096
    ds_read_b64_tr_b16 v[186:187], v244 offset:5120
    v_mfma_f32_32x32x16_bf16 v[32:47], v[204:207], v[192:195], v[32:47]
    ds_read_b64_tr_b16 v[188:189], v245 offset:4096
    ds_read_b64_tr_b16 v[190:191], v245 offset:5120
    s_waitcnt vmcnt(28) lgkmcnt(0)
    v_mfma_f32_32x32x16_bf16 v[48:63], v[216:219], v[212:215], v[48:63]
    ds_write_b32 v253, v255 offset:16
    s_waitcnt vmcnt(4)
    s_mul_i32 s56, s44, 4096
    v_mfma_f32_32x32x16_bf16 v[64:79], v[220:223], v[212:215], v[64:79]
    buffer_load_dwordx4 v[192:195], v10, s[36:39], s56 offen offset:1024 sc1
    buffer_load_dwordx4 v[196:199], v11, s[36:39], s56 offen offset:1024 sc1
    s_waitcnt vmcnt(4)
    s_add_u32 m0, s5, 12288
    s_mov_b32 s56, 86016
    buffer_load_dwordx4 v246, s[28:31], s56 offen lds
    v_mfma_f32_32x32x16_bf16 v[16:31], v[216:219], v[208:211], v[16:31]
    s_waitcnt vmcnt(35)
    ds_read_b64_tr_b16 v[200:201], v12 offset:0
    ds_read_b64_tr_b16 v[202:203], v12 offset:1024
    v_mfma_f32_32x32x16_bf16 v[32:47], v[220:223], v[208:211], v[32:47]
    ds_read_b64_tr_b16 v[204:205], v8 offset:0
    ds_read_b64_tr_b16 v[206:207], v8 offset:1024
    s_waitcnt vmcnt(26) lgkmcnt(0)
    v_mfma_f32_32x32x16_bf16 v[48:63], v[232:235], v[228:231], v[48:63]
    s_waitcnt vmcnt(4)
    s_add_u32 m0, s47, 0
    s_mul_i32 s56, s45, 57344
    s_add_u32 s56, s56, 14336
    buffer_load_dwordx4 v14, s[32:35], s56 offen lds
    buffer_load_dwordx4 v15, s[32:35], s56 offen offset:1024 lds
    s_waitcnt vmcnt(4)
    v_mfma_f32_32x32x16_bf16 v[64:79], v[236:239], v[228:231], v[64:79]
    s_mul_i32 s56, s44, 4096
    buffer_load_dwordx4 v[208:211], v10, s[36:39], s56 offen offset:2048 sc1
    buffer_load_dwordx4 v[212:215], v11, s[36:39], s56 offen offset:2048 sc1
    v_mfma_f32_32x32x16_bf16 v[16:31], v[232:235], v[224:227], v[16:31]
    s_waitcnt vmcnt(4)
    s_add_u32 m0, s5, 13312
    s_mov_b32 s56, 93184
    buffer_load_dwordx4 v246, s[28:31], s56 offen lds
    s_waitcnt vmcnt(33)
    ds_read_b64_tr_b16 v[216:217], v12 offset:2048
    v_mfma_f32_32x32x16_bf16 v[32:47], v[236:239], v[224:227], v[32:47]
    ds_read_b64_tr_b16 v[218:219], v12 offset:3072
    ds_read_b64_tr_b16 v[220:221], v8 offset:2048
    ds_read_b64_tr_b16 v[222:223], v8 offset:3072
    s_waitcnt vmcnt(29) lgkmcnt(0)
    v_mfma_f32_32x32x16_bf16 v[48:63], v[88:91], v[84:87], v[48:63]
    s_waitcnt vmcnt(4)
    s_add_u32 m0, s47, 2048
    s_mul_i32 s56, s45, 57344
    s_add_u32 s56, s56, 28672
    buffer_load_dwordx4 v14, s[32:35], s56 offen lds
    buffer_load_dwordx4 v15, s[32:35], s56 offen offset:1024 lds
    s_waitcnt vmcnt(4)
    v_mfma_f32_32x32x16_bf16 v[64:79], v[92:95], v[84:87], v[64:79]
    s_mul_i32 s56, s44, 4096
    buffer_load_dwordx4 v[224:227], v10, s[36:39], s56 offen offset:3072 sc1
    buffer_load_dwordx4 v[228:231], v11, s[36:39], s56 offen offset:3072 sc1
    v_mfma_f32_32x32x16_bf16 v[16:31], v[88:91], v[80:83], v[16:31]
    s_waitcnt vmcnt(4)
    s_add_u32 m0, s5, 14336
    s_mov_b32 s56, 100352
    buffer_load_dwordx4 v246, s[28:31], s56 offen lds
    s_waitcnt vmcnt(31)
    ds_read_b64_tr_b16 v[232:233], v12 offset:4096
    v_mfma_f32_32x32x16_bf16 v[32:47], v[92:95], v[80:83], v[32:47]
    ds_read_b64_tr_b16 v[234:235], v12 offset:5120
    ds_read_b64_tr_b16 v[236:237], v8 offset:4096
    ds_read_b64_tr_b16 v[238:239], v8 offset:5120
    s_waitcnt vmcnt(29) lgkmcnt(0)
    v_mfma_f32_32x32x16_bf16 v[48:63], v[104:107], v[100:103], v[48:63]
    s_waitcnt vmcnt(4)
    s_add_u32 m0, s47, 4096
    s_mul_i32 s56, s45, 57344
    s_add_u32 s56, s56, 43008
    buffer_load_dwordx4 v14, s[32:35], s56 offen lds
    buffer_load_dwordx4 v15, s[32:35], s56 offen offset:1024 lds
    s_waitcnt vmcnt(4)
    v_mfma_f32_32x32x16_bf16 v[64:79], v[108:111], v[100:103], v[64:79]
    s_mul_i32 s56, s45, 4096
    buffer_load_dwordx4 v[80:83], v10, s[36:39], s56 offen offset:0 sc1
    buffer_load_dwordx4 v[84:87], v11, s[36:39], s56 offen offset:0 sc1
    v_mfma_f32_32x32x16_bf16 v[16:31], v[104:107], v[96:99], v[16:31]
    buffer_load_dwordx4 v[240:243], v247, s[36:39], 0 offen sc1
    buffer_load_dwordx2 v[4:5], v254, s[36:39], 0 offen sc1
    s_waitcnt vmcnt(30)
    ds_read_b64_tr_b16 v[88:89], v12 offset:6144
    v_mfma_f32_32x32x16_bf16 v[32:47], v[108:111], v[96:99], v[32:47]
    ds_read_b64_tr_b16 v[90:91], v12 offset:7168
    ds_read_b64_tr_b16 v[92:93], v8 offset:6144
    ds_read_b64_tr_b16 v[94:95], v8 offset:7168
    s_waitcnt vmcnt(33) lgkmcnt(0)
    v_mfma_f32_32x32x16_bf16 v[48:63], v[120:123], v[116:119], v[48:63]
    s_waitcnt vmcnt(4)
    s_add_u32 m0, s47, 6144
    s_mul_i32 s56, s46, 57344
    s_add_u32 s56, s56, 0
    buffer_load_dwordx4 v14, s[32:35], s56 offen lds
    buffer_load_dwordx4 v15, s[32:35], s56 offen offset:1024 lds
    v_mfma_f32_32x32x16_bf16 v[64:79], v[124:127], v[116:119], v[64:79]
    s_waitcnt vmcnt(4)
    s_mul_i32 s56, s45, 4096
    buffer_load_dwordx4 v[96:99], v10, s[36:39], s56 offen offset:1024 sc1
    v_mfma_f32_32x32x16_bf16 v[16:31], v[120:123], v[112:115], v[16:31]
    buffer_load_dwordx4 v[100:103], v11, s[36:39], s56 offen offset:1024 sc1
    s_waitcnt vmcnt(18)
    ds_read_b64_tr_b16 v[104:105], v12 offset:0
    v_mfma_f32_32x32x16_bf16 v[32:47], v[124:127], v[112:115], v[32:47]
    ds_read_b64_tr_b16 v[106:107], v12 offset:1024
    ds_read_b64_tr_b16 v[108:109], v8 offset:0
    ds_read_b64_tr_b16 v[110:111], v8 offset:1024
    s_waitcnt vmcnt(32) lgkmcnt(0)
    v_mfma_f32_32x32x16_bf16 v[48:63], v[136:139], v[132:135], v[48:63]
    s_waitcnt vmcnt(4)
    s_add_u32 m0, s47, 0
    s_mul_i32 s56, s46, 57344
    s_add_u32 s56, s56, 14336
    buffer_load_dwordx4 v14, s[32:35], s56 offen lds
    buffer_load_dwordx4 v15, s[32:35], s56 offen offset:1024 lds
    v_mfma_f32_32x32x16_bf16 v[64:79], v[140:143], v[132:135], v[64:79]
    s_waitcnt vmcnt(4)
    s_mul_i32 s56, s45, 4096
    buffer_load_dwordx4 v[112:115], v10, s[36:39], s56 offen offset:2048 sc1
    v_mfma_f32_32x32x16_bf16 v[16:31], v[136:139], v[128:131], v[16:31]
    buffer_load_dwordx4 v[116:119], v11, s[36:39], s56 offen offset:2048 sc1
    s_waitcnt vmcnt(17)
    ds_read_b64_tr_b16 v[120:121], v12 offset:2048
    v_mfma_f32_32x32x16_bf16 v[32:47], v[140:143], v[128:131], v[32:47]
    ds_read_b64_tr_b16 v[122:123], v12 offset:3072
    ds_read_b64_tr_b16 v[124:125], v8 offset:2048
    ds_read_b64_tr_b16 v[126:127], v8 offset:3072
    s_setprio 2
    s_mov_b32 s61, 40000
    s_waitcnt vmcnt(8)
    v_cmp_ne_u64 vcc, s[62:63], v[4:5]
    s_cbranch_vccz PLD_17
PL_16:
    buffer_load_dwordx2 v[4:5], v254, s[36:39], 0 offen sc1
    s_waitcnt vmcnt(0)
    v_cmp_ne_u64 vcc, s[62:63], v[4:5]
    s_cbranch_vccz PLD_17
    s_sleep 4
    s_sub_u32 s61, s61, 1
    s_cmp_lg_u32 s61, 0
    s_cbranch_scc1 PL_16
PLD_17:
    s_mov_b32 s61, 40000
    s_waitcnt vmcnt(9)
SC_19:
    v_cmp_ne_u64 vcc, s[62:63], v[242:243]
    s_cbranch_vccz SCD_20
    buffer_load_dwordx4 v[240:243], v247, s[36:39], 0 offen sc1
    s_sub_u32 s61, s61, 1
    s_cmp_lg_u32 s61, 0
    s_waitcnt vmcnt(0)
    s_cbranch_scc1 SC_19
SCD_20:
    v_mov_b32 v6, v240
    v_mov_b32 v3, 158724
    s_setprio 0
    s_waitcnt vmcnt(14)
    ds_write_b32 v253, v255 offset:128
    s_waitcnt vmcnt(34) lgkmcnt(0)
    v_mfma_f32_32x32x16_bf16 v[48:63], v[152:155], v[148:151], v[48:63]
    s_waitcnt vmcnt(4)
    s_add_u32 m0, s47, 2048
    s_mul_i32 s56, s46, 57344
    s_add_u32 s56, s56, 28672
    buffer_load_dwordx4 v14, s[32:35], s56 offen lds
    buffer_load_dwordx4 v15, s[32:35], s56 offen offset:1024 lds
    v_mfma_f32_32x32x16_bf16 v[64:79], v[156:159], v[148:151], v[64:79]
    s_waitcnt vmcnt(4)
    s_mul_i32 s56, s45, 4096
    buffer_load_dwordx4 v[128:131], v10, s[36:39], s56 offen offset:3072 sc1
    v_mfma_f32_32x32x16_bf16 v[16:31], v[152:155], v[144:147], v[16:31]
    buffer_load_dwordx4 v[132:135], v11, s[36:39], s56 offen offset:3072 sc1
    s_waitcnt vmcnt(16)
    ds_read_b64_tr_b16 v[136:137], v12 offset:4096
    v_mfma_f32_32x32x16_bf16 v[32:47], v[156:159], v[144:147], v[32:47]
    ds_read_b64_tr_b16 v[138:139], v12 offset:5120
    ds_read_b64_tr_b16 v[140:141], v8 offset:4096
    ds_read_b64_tr_b16 v[142:143], v8 offset:5120
    s_waitcnt vmcnt(35) lgkmcnt(0)
    v_mfma_f32_32x32x16_bf16 v[48:63], v[168:171], v[164:167], v[48:63]
    s_waitcnt vmcnt(4)
    s_add_u32 m0, s47, 4096
    s_mul_i32 s56, s46, 57344
    s_add_u32 s56, s56, 43008
    buffer_load_dwordx4 v14, s[32:35], s56 offen lds
    buffer_load_dwordx4 v15, s[32:35], s56 offen offset:1024 lds
    v_mfma_f32_32x32x16_bf16 v[64:79], v[172:175], v[164:167], v[64:79]
    s_waitcnt vmcnt(4)
    s_mul_i32 s56, s46, 4096
    buffer_load_dwordx4 v[144:147], v10, s[36:39], s56 offen offset:0 sc1
    v_mfma_f32_32x32x16_bf16 v[16:31], v[168:171], v[160:163], v[16:31]
    buffer_load_dwordx4 v[148:151], v11, s[36:39], s56 offen offset:0 sc1
    s_waitcnt vmcnt(14)
    ds_read_b64_tr_b16 v[152:153], v12 offset:6144
    v_mfma_f32_32x32x16_bf16 v[32:47], v[172:175], v[160:163], v[32:47]
    ds_read_b64_tr_b16 v[154:155], v12 offset:7168
    ds_read_b64_tr_b16 v[156:157], v8 offset:6144
    ds_read_b64_tr_b16 v[158:159], v8 offset:7168
    s_waitcnt vmcnt(36) lgkmcnt(0)
    v_mfma_f32_32x32x16_bf16 v[48:63], v[184:187], v[180:183], v[48:63]
    s_waitcnt vmcnt(4)
    s_mul_i32 s56, s46, 4096
    buffer_load_dwordx4 v[160:163], v10, s[36:39], s56 offen offset:1024 sc1
    v_mfma_f32_32x32x16_bf16 v[64:79], v[188:191], v[180:183], v[64:79]
    buffer_load_dwordx4 v[164:167], v11, s[36:39], s56 offen offset:1024 sc1
    s_waitcnt vmcnt(12)
    v_mfma_f32_32x32x16_bf16 v[16:31], v[184:187], v[176:179], v[16:31]
    ds_read_b64_tr_b16 v[168:169], v12 offset:0
    ds_read_b64_tr_b16 v[170:171], v12 offset:1024
    v_mfma_f32_32x32x16_bf16 v[32:47], v[188:191], v[176:179], v[32:47]
    ds_read_b64_tr_b16 v[172:173], v8 offset:0
    ds_read_b64_tr_b16 v[174:175], v8 offset:1024
    s_waitcnt vmcnt(35) lgkmcnt(0)
    v_mfma_f32_32x32x16_bf16 v[48:63], v[200:203], v[196:199], v[48:63]
    s_waitcnt vmcnt(4)
    s_mul_i32 s56, s46, 4096
    buffer_load_dwordx4 v[176:179], v10, s[36:39], s56 offen offset:2048 sc1
    v_mfma_f32_32x32x16_bf16 v[64:79], v[204:207], v[196:199], v[64:79]
    buffer_load_dwordx4 v[180:183], v11, s[36:39], s56 offen offset:2048 sc1
    s_waitcnt vmcnt(10)
    v_mfma_f32_32x32x16_bf16 v[16:31], v[200:203], v[192:195], v[16:31]
    ds_read_b64_tr_b16 v[184:185], v12 offset:2048
    ds_read_b64_tr_b16 v[186:187], v12 offset:3072
    v_mfma_f32_32x32x16_bf16 v[32:47], v[204:207], v[192:195], v[32:47]
    ds_read_b64_tr_b16 v[188:189], v8 offset:2048
    ds_read_b64_tr_b16 v[190:191], v8 offset:3072
    s_waitcnt vmcnt(32) lgkmcnt(0)
    v_mfma_f32_32x32x16_bf16 v[48:63], v[216:219], v[212:215], v[48:63]
    s_waitcnt vmcnt(4)
    s_mul_i32 s56, s46, 4096
    buffer_load_dwordx4 v[192:195], v10, s[36:39], s56 offen offset:3072 sc1
    v_mfma_f32_32x32x16_bf16 v[64:79], v[220:223], v[212:215], v[64:79]
    buffer_load_dwordx4 v[196:199], v11, s[36:39], s56 offen offset:3072 sc1
    s_waitcnt vmcnt(8)
    v_mfma_f32_32x32x16_bf16 v[16:31], v[216:219], v[208:211], v[16:31]
    ds_read_b64_tr_b16 v[200:201], v12 offset:4096
    ds_read_b64_tr_b16 v[202:203], v12 offset:5120
    v_mfma_f32_32x32x16_bf16 v[32:47], v[220:223], v[208:211], v[32:47]
    ds_read_b64_tr_b16 v[204:205], v8 offset:4096
    ds_read_b64_tr_b16 v[206:207], v8 offset:5120
    s_mov_b32 s28, s16
    s_mov_b32 s29, s17
    s_mov_b32 s30, 1835008
    s_mov_b32 s31, 0x00020000
    buffer_load_dwordx4 v[240:243], v9, s[24:27], 0 offen
    buffer_load_dwordx4 v[244:247], v9, s[24:27], 0 offen offset:16
    ds_write_b32 v253, v255 offset:160
    s_mov_b32 s61, 320000
LS_21:
    ds_read_b32 v4, v3 offset:188
    s_waitcnt lgkmcnt(0)
    v_cmp_eq_u32 vcc, -1, v4
    s_cbranch_vccz LSD_22
    s_sleep 2
    s_sub_u32 s61, s61, 1
    s_cmp_lg_u32 s61, 0
    s_cbranch_scc1 LS_21
LSD_22:
    s_waitcnt vmcnt(31) lgkmcnt(0)
    v_mfma_f32_32x32x16_bf16 v[48:63], v[232:235], v[228:231], v[48:63]
    v_mfma_f32_32x32x16_bf16 v[64:79], v[236:239], v[228:231], v[64:79]
    v_mfma_f32_32x32x16_bf16 v[16:31], v[232:235], v[224:227], v[16:31]
    v_mfma_f32_32x32x16_bf16 v[32:47], v[236:239], v[224:227], v[32:47]
    s_waitcnt vmcnt(26) lgkmcnt(0)
    v_mfma_f32_32x32x16_bf16 v[48:63], v[88:91], v[84:87], v[48:63]
    v_mfma_f32_32x32x16_bf16 v[64:79], v[92:95], v[84:87], v[64:79]
    v_mfma_f32_32x32x16_bf16 v[16:31], v[88:91], v[80:83], v[16:31]
    v_mfma_f32_32x32x16_bf16 v[32:47], v[92:95], v[80:83], v[32:47]
    s_waitcnt vmcnt(20) lgkmcnt(0)
    v_mfma_f32_32x32x16_bf16 v[48:63], v[104:107], v[100:103], v[48:63]
    v_mfma_f32_32x32x16_bf16 v[64:79], v[108:111], v[100:103], v[64:79]
    v_mfma_f32_32x32x16_bf16 v[16:31], v[104:107], v[96:99], v[16:31]
    v_mfma_f32_32x32x16_bf16 v[32:47], v[108:111], v[96:99], v[32:47]
    s_waitcnt vmcnt(16) lgkmcnt(0)
    v_mfma_f32_32x32x16_bf16 v[48:63], v[120:123], v[116:119], v[48:63]
    v_mfma_f32_32x32x16_bf16 v[64:79], v[124:127], v[116:119], v[64:79]
    v_mfma_f32_32x32x16_bf16 v[16:31], v[120:123], v[112:115], v[16:31]
    v_mfma_f32_32x32x16_bf16 v[32:47], v[124:127], v[112:115], v[32:47]
    s_waitcnt vmcnt(12) lgkmcnt(0)
    v_mfma_f32_32x32x16_bf16 v[48:63], v[136:139], v[132:135], v[48:63]
    v_mfma_f32_32x32x16_bf16 v[64:79], v[140:143], v[132:135], v[64:79]
    v_mfma_f32_32x32x16_bf16 v[16:31], v[136:139], v[128:131], v[16:31]
    v_mfma_f32_32x32x16_bf16 v[32:47], v[140:143], v[128:131], v[32:47]
    s_waitcnt vmcnt(8) lgkmcnt(0)
    v_mfma_f32_32x32x16_bf16 v[48:63], v[152:155], v[148:151], v[48:63]
    v_mfma_f32_32x32x16_bf16 v[64:79], v[156:159], v[148:151], v[64:79]
    v_mfma_f32_32x32x16_bf16 v[16:31], v[152:155], v[144:147], v[16:31]
    v_mfma_f32_32x32x16_bf16 v[32:47], v[156:159], v[144:147], v[32:47]
    s_waitcnt vmcnt(6) lgkmcnt(0)
    v_mfma_f32_32x32x16_bf16 v[48:63], v[168:171], v[164:167], v[48:63]
    v_mfma_f32_32x32x16_bf16 v[64:79], v[172:175], v[164:167], v[64:79]
    v_mfma_f32_32x32x16_bf16 v[16:31], v[168:171], v[160:163], v[16:31]
    v_mfma_f32_32x32x16_bf16 v[32:47], v[172:175], v[160:163], v[32:47]
    s_waitcnt vmcnt(4) lgkmcnt(0)
    v_mfma_f32_32x32x16_bf16 v[48:63], v[184:187], v[180:183], v[48:63]
    v_mfma_f32_32x32x16_bf16 v[64:79], v[188:191], v[180:183], v[64:79]
    v_mfma_f32_32x32x16_bf16 v[16:31], v[184:187], v[176:179], v[16:31]
    v_mfma_f32_32x32x16_bf16 v[32:47], v[188:191], v[176:179], v[32:47]
    s_waitcnt vmcnt(2) lgkmcnt(0)
    v_mfma_f32_32x32x16_bf16 v[48:63], v[200:203], v[196:199], v[48:63]
    v_mfma_f32_32x32x16_bf16 v[64:79], v[204:207], v[196:199], v[64:79]
    v_mfma_f32_32x32x16_bf16 v[16:31], v[200:203], v[192:195], v[16:31]
    v_mfma_f32_32x32x16_bf16 v[32:47], v[204:207], v[192:195], v[32:47]
    s_setprio 2
    v_xor_b32 v4, 8, v253
    s_waitcnt vmcnt(0)
    s_nop 7
    ds_write_b128 v251, v[48:51] offset:0
    ds_write_b128 v251, v[52:55] offset:1024
    ds_write_b128 v251, v[56:59] offset:2048
    ds_write_b128 v251, v[60:63] offset:3072
    ds_write_b128 v251, v[64:67] offset:4096
    ds_write_b128 v251, v[68:71] offset:5120
    ds_write_b128 v251, v[72:75] offset:6144
    ds_write_b128 v251, v[76:79] offset:7168
    ds_write_b32 v253, v255 offset:32
    v_lshlrev_b32 v208, 16, v240
    v_and_b32 v209, 0xffff0000, v240
    v_lshlrev_b32 v210, 16, v241
    v_and_b32 v211, 0xffff0000, v241
    v_lshlrev_b32 v212, 16, v242
    v_and_b32 v213, 0xffff0000, v242
    v_lshlrev_b32 v214, 16, v243
    v_and_b32 v215, 0xffff0000, v243
    v_lshlrev_b32 v216, 16, v244
    v_and_b32 v217, 0xffff0000, v244
    v_lshlrev_b32 v218, 16, v245
    v_and_b32 v219, 0xffff0000, v245
    v_lshlrev_b32 v220, 16, v246
    v_and_b32 v221, 0xffff0000, v246
    v_lshlrev_b32 v222, 16, v247
    v_and_b32 v223, 0xffff0000, v247
    s_mov_b32 s61, 320000
LS_23:
    ds_read_b32 v5, v4 offset:32
    s_waitcnt lgkmcnt(0)
    v_cmp_eq_u32 vcc, -1, v5
    s_cbranch_vccz LSD_24
    s_sub_u32 s61, s61, 1
    s_cmp_lg_u32 s61, 0
    s_cbranch_scc1 LS_23
LSD_24:
    ds_read_b128 v[64:67], v252 offset:4096
    ds_read_b128 v[68:71], v252 offset:5120
    ds_read_b128 v[72:75], v252 offset:6144
    ds_read_b128 v[76:79], v252 offset:7168
    ds_read_b128 v[48:51], v252 offset:0
    ds_read_b128 v[52:55], v252 offset:1024
    ds_read_b128 v[56:59], v252 offset:2048
    ds_read_b128 v[60:63], v252 offset:3072
    s_waitcnt lgkmcnt(4)
    v_add_f32 v32, v32, v64
    v_add_f32 v33, v33, v65
    v_add_f32 v34, v34, v66
    v_add_f32 v35, v35, v67
    v_add_f32 v36, v36, v68
    v_add_f32 v37, v37, v69
    v_add_f32 v38, v38, v70
    v_add_f32 v39, v39, v71
    v_add_f32 v40, v40, v72
    v_add_f32 v41, v41, v73
    v_add_f32 v42, v42, v74
    v_add_f32 v43, v43, v75
    v_add_f32 v44, v44, v76
    v_add_f32 v45, v45, v77
    v_add_f32 v46, v46, v78
    v_add_f32 v47, v47, v79
    s_waitcnt lgkmcnt(0)
    ds_write_b128 v252, v[32:35] offset:0
    ds_write_b128 v252, v[36:39] offset:1024
    ds_write_b128 v252, v[40:43] offset:2048
    ds_write_b128 v252, v[44:47] offset:3072
    ds_write_b32 v253, v255 offset:48
    v_add_f32 v16, v16, v48
    v_add_f32 v17, v17, v49
    v_add_f32 v18, v18, v50
    v_add_f32 v19, v19, v51
    v_add_f32 v20, v20, v52
    v_add_f32 v21, v21, v53
    v_add_f32 v22, v22, v54
    v_add_f32 v23, v23, v55
    v_add_f32 v24, v24, v56
    v_add_f32 v25, v25, v57
    v_add_f32 v26, v26, v58
    v_add_f32 v27, v27, v59
    v_add_f32 v28, v28, v60
    v_add_f32 v29, v29, v61
    v_add_f32 v30, v30, v62
    v_add_f32 v31, v31, v63
    s_mov_b32 s61, 320000
LS_25:
    ds_read_b32 v5, v7
    s_waitcnt lgkmcnt(0)
    v_cmp_eq_u32 vcc, -1, v5
    s_cbranch_vccz LSD_26
    s_sleep 1
    s_sub_u32 s61, s61, 1
    s_cmp_lg_u32 s61, 0
    s_cbranch_scc1 LS_25
LSD_26:
    ds_read_b128 v[32:35], v13 offset:0
    ds_read_b128 v[48:51], v248 offset:0
    ds_read_b128 v[64:67], v249 offset:4096
    ds_read_b128 v[36:39], v13 offset:1024
    ds_read_b128 v[52:55], v248 offset:1024
    ds_read_b128 v[68:71], v249 offset:5120
    ds_read_b128 v[40:43], v13 offset:2048
    ds_read_b128 v[56:59], v248 offset:2048
    ds_read_b128 v[72:75], v249 offset:6144
    ds_read_b128 v[44:47], v13 offset:3072
    ds_read_b128 v[60:63], v248 offset:3072
    ds_read_b128 v[76:79], v249 offset:7168
    s_waitcnt lgkmcnt(6)
    v_add_f32 v16, v16, v32
    v_add_f32 v17, v17, v33
    v_add_f32 v18, v18, v34
    v_add_f32 v19, v19, v35
    v_add_f32 v20, v20, v36
    v_add_f32 v21, v21, v37
    v_add_f32 v22, v22, v38
    v_add_f32 v23, v23, v39
    v_add_f32 v48, v48, v64
    v_add_f32 v49, v49, v65
    v_add_f32 v50, v50, v66
    v_add_f32 v51, v51, v67
    v_add_f32 v52, v52, v68
    v_add_f32 v53, v53, v69
    v_add_f32 v54, v54, v70
    v_add_f32 v55, v55, v71
    v_fma_f32 v16, v16, v6, v208
    v_fma_f32 v17, v17, v6, v209
    v_fma_f32 v18, v18, v6, v210
    v_fma_f32 v19, v19, v6, v211
    v_fma_f32 v20, v20, v6, v212
    v_fma_f32 v21, v21, v6, v213
    v_fma_f32 v22, v22, v6, v214
    v_fma_f32 v23, v23, v6, v215
    v_add_f32 v16, v16, v48
    v_add_f32 v17, v17, v49
    v_add_f32 v18, v18, v50
    v_add_f32 v19, v19, v51
    v_add_f32 v20, v20, v52
    v_add_f32 v21, v21, v53
    v_add_f32 v22, v22, v54
    v_add_f32 v23, v23, v55
    v_cvt_pk_bf16_f32 v16, v16, v17
    v_cvt_pk_bf16_f32 v17, v18, v19
    v_cvt_pk_bf16_f32 v18, v20, v21
    v_cvt_pk_bf16_f32 v19, v22, v23
    buffer_store_dwordx4 v[16:19], v9, s[28:31], 0 offen offset:0
    s_waitcnt lgkmcnt(0)
    v_add_f32 v24, v24, v40
    v_add_f32 v25, v25, v41
    v_add_f32 v26, v26, v42
    v_add_f32 v27, v27, v43
    v_add_f32 v28, v28, v44
    v_add_f32 v29, v29, v45
    v_add_f32 v30, v30, v46
    v_add_f32 v31, v31, v47
    v_add_f32 v56, v56, v72
    v_add_f32 v57, v57, v73
    v_add_f32 v58, v58, v74
    v_add_f32 v59, v59, v75
    v_add_f32 v60, v60, v76
    v_add_f32 v61, v61, v77
    v_add_f32 v62, v62, v78
    v_add_f32 v63, v63, v79
    v_fma_f32 v24, v24, v6, v216
    v_fma_f32 v25, v25, v6, v217
    v_fma_f32 v26, v26, v6, v218
    v_fma_f32 v27, v27, v6, v219
    v_fma_f32 v28, v28, v6, v220
    v_fma_f32 v29, v29, v6, v221
    v_fma_f32 v30, v30, v6, v222
    v_fma_f32 v31, v31, v6, v223
    v_add_f32 v24, v24, v56
    v_add_f32 v25, v25, v57
    v_add_f32 v26, v26, v58
    v_add_f32 v27, v27, v59
    v_add_f32 v28, v28, v60
    v_add_f32 v29, v29, v61
    v_add_f32 v30, v30, v62
    v_add_f32 v31, v31, v63
    v_cvt_pk_bf16_f32 v24, v24, v25
    v_cvt_pk_bf16_f32 v25, v26, v27
    v_cvt_pk_bf16_f32 v26, v28, v29
    v_cvt_pk_bf16_f32 v27, v30, v31
    buffer_store_dwordx4 v[24:27], v9, s[28:31], 0 offen offset:16
    s_or_b32 s53, s2, s49
    s_cmp_lg_u32 s53, 0
    s_cbranch_scc1 F_NOEP
    s_mov_b32 s53, 19136512
    v_lshl_add_u32 v13, v0, 3, s53
    v_mov_b32 v14, s62
    v_mov_b32 v15, s63
    s_mov_b64 exec, 0xffff
    buffer_store_dwordx2 v[14:15], v13, s[36:39], 0 offen sc1
    s_mov_b64 exec, -1
F_NOEP:
END:
    s_endpgm
A_ENTRY:
    s_setprio 3
    s_waitcnt lgkmcnt(0)
    s_mov_b32 s36, s20
    s_mov_b32 s37, s21
    s_mov_b32 s38, 268435456
    s_mov_b32 s39, 0x00020000
    v_mov_b32 v243, 19136512
    buffer_load_dword v243, v243, s[36:39], 0 offen sc1
    s_setprio 1
    v_and_b32 v1, 31, v0
    v_lshrrev_b32 v2, 5, v0
    s_mov_b32 s3, 0x3f803f80
    s_mov_b32 s22, 0
    s_mov_b32 s23, -1
    s_lshr_b32 s53, s2, 4
    s_lshl_b32 s53, s53, 2
    s_add_u32 s53, s53, s49
    s_mul_i32 s53, s53, 147456
    s_and_b32 s54, s2, 15
    s_lshl_b32 s54, s54, 11
    s_add_u32 s53, s53, s54
    s_add_u32 s53, s53, 6406144
    v_lshl_add_u32 v13, v0, 4, s53
    s_and_b32 s47, s2, 31
    s_lshl_b32 s47, s47, 11
    s_add_u32 s47, s47, 4194304
    v_bfe_u32 v3, v1, 1, 3
    v_xor_b32 v3, v3, v2
    v_lshlrev_b32 v4, 7, v1
    v_lshl_add_u32 v4, v3, 4, v4
    v_add_u32 v4, s57, v4
    v_bfe_u32 v5, v0, 2, 2
    v_lshl_add_u32 v6, v2, 3, v5
    v_bfe_u32 v7, v0, 4, 1
    v_lshlrev_b32 v7, 5, v7
    v_and_b32 v8, 3, v0
    v_lshl_add_u32 v7, v8, 3, v7
    v_mul_u32_u24 v8, 192, v6
    v_add_u32 v8, v8, v7
    s_add_u32 s53, s49, 0
    s_and_b32 s53, s53, 3
    s_lshl_b32 s54, s53, 5
    v_xor_b32 v20, s54, v4
    s_mul_i32 s54, s53, 3072
    s_add_u32 s54, s54, 114688
    v_add_u32 v24, s54, v8
    s_add_u32 s53, s49, 1
    s_and_b32 s53, s53, 3
    s_lshl_b32 s54, s53, 5
    v_xor_b32 v21, s54, v4
    s_mul_i32 s54, s53, 3072
    s_add_u32 s54, s54, 114688
    v_add_u32 v25, s54, v8
    s_add_u32 s53, s49, 2
    s_and_b32 s53, s53, 3
    s_lshl_b32 s54, s53, 5
    v_xor_b32 v22, s54, v4
    s_mul_i32 s54, s53, 3072
    s_add_u32 s54, s54, 114688
    v_add_u32 v26, s54, v8
    s_add_u32 s53, s49, 3
    s_and_b32 s53, s53, 3
    s_lshl_b32 s54, s53, 5
    v_xor_b32 v23, s54, v4
    s_mul_i32 s54, s53, 3072
    s_add_u32 s54, s54, 114688
    v_add_u32 v27, s54, v8
    v_lshrrev_b32 v3, 2, v0
    v_xor_b32 v3, v3, v0
    v_bfe_u32 v3, v3, 2, 1
    v_add_u32 v3, -1, v3
    v_and_b32 v188, s3, v3
    v_mov_b32 v189, v188
    v_mov_b32 v190, v188
    v_mov_b32 v191, v188
    s_lshl_b32 s54, s52, 11
    s_mul_i32 s53, s60, 2097152
    s_add_u32 s54, s54, s53
    v_lshl_add_u32 v3, v1, 4, s54
    v_lshl_add_u32 v28, v2, 3, v3
    v_lshl_add_u32 v29, v2, 17, v3
    s_cmp_eq_u32 s60, 0
    s_mov_b32 s58, 0x3e8b97f6
    s_cselect_b32 s58, s58, 1.0
    s_mul_i32 s53, s52, 28672
    s_lshl_b32 s54, s51, 11
    s_add_u32 s53, s53, s54
    s_add_u32 s53, s53, 20971520
    v_lshl_add_u32 v30, v0, 4, s53
    s_lshl_b32 s53, s49, 2
    s_add_u32 s53, s53, 151552
    v_lshl_add_u32 v31, v0, 4, s53
    s_lshl_b32 s53, s49, 7
    s_add_u32 s53, s53, 159744
    v_lshl_add_u32 v200, v1, 2, s53
    v_lshl_add_u32 v201, v2, 4, s53
    s_lshl_b32 s53, s49, 9
    s_add_u32 s53, s53, 154624
    v_lshl_add_u32 v202, v0, 2, s53
    s_mul_i32 s53, s49, 448
    v_lshrrev_b32 v3, 3, v0
    v_add_u32 v4, s53, v3
    v_mul_u32_u24 v4, 896, v4
    v_lshrrev_b32 v5, 2, v0
    v_and_b32 v5, 4, v5
    v_and_b32 v6, 7, v0
    v_xor_b32 v5, v5, v6
    v_lshl_add_u32 v4, v5, 4, v4
    s_lshl_b32 s53, s59, 7
    s_mul_i32 s54, s40, 57344
    s_add_u32 s53, s53, s54
    v_add_u32 v249, s53, v4
    s_lshl_b32 s41, s49, 13
    s_add_u32 s41, s41, 114688
    s_mov_b32 s32, s14
    s_mov_b32 s33, s15
    s_mov_b32 s34, 1605632
    s_mov_b32 s35, 0x00020000
    v_mov_b32 v128, 0
    v_mov_b32 v129, 0
    v_mov_b32 v130, 0
    v_mov_b32 v131, 0
    v_mov_b32 v132, 0
    v_mov_b32 v133, 0
    v_mov_b32 v134, 0
    v_mov_b32 v135, 0
    v_mov_b32 v136, 0
    v_mov_b32 v137, 0
    v_mov_b32 v138, 0
    v_mov_b32 v139, 0
    v_mov_b32 v140, 0
    v_mov_b32 v141, 0
    v_mov_b32 v142, 0
    v_mov_b32 v143, 0
    v_mov_b32 v144, 0
    v_mov_b32 v145, 0
    v_mov_b32 v146, 0
    v_mov_b32 v147, 0
    v_mov_b32 v148, 0
    v_mov_b32 v149, 0
    v_mov_b32 v150, 0
    v_mov_b32 v151, 0
    v_mov_b32 v152, 0
    v_mov_b32 v153, 0
    v_mov_b32 v154, 0
    v_mov_b32 v155, 0
    v_mov_b32 v156, 0
    v_mov_b32 v157, 0
    v_mov_b32 v158, 0
    v_mov_b32 v159, 0
    v_mov_b32 v160, 0
    v_mov_b32 v161, 0
    v_mov_b32 v162, 0
    v_mov_b32 v163, 0
    v_mov_b32 v164, 0
    v_mov_b32 v165, 0
    v_mov_b32 v166, 0
    v_mov_b32 v167, 0
    v_mov_b32 v168, 0
    v_mov_b32 v169, 0
    v_mov_b32 v170, 0
    v_mov_b32 v171, 0
    v_mov_b32 v172, 0
    v_mov_b32 v173, 0
    v_mov_b32 v174, 0
    v_mov_b32 v175, 0
    v_mov_b32 v176, 0
    v_mov_b32 v177, 0
    v_mov_b32 v178, 0
    v_mov_b32 v179, 0
    v_mov_b32 v180, 0
    v_mov_b32 v181, 0
    v_mov_b32 v182, 0
    v_mov_b32 v183, 0
    v_mov_b32 v184, 0
    v_mov_b32 v185, 0
    v_mov_b32 v186, 0
    v_mov_b32 v187, 0
    s_mov_b32 s44, s59
    s_lshl_b32 s45, s59, 18
    s_mov_b32 s12, 0
    s_lshr_b32 s53, s44, 2
    s_lshl_b32 s53, s53, 17
    s_and_b32 s54, s44, 3
    s_lshl_b32 s54, s54, 9
    s_add_u32 s53, s53, s54
    s_add_u32 s4, s53, s45
    s_cmp_eq_u32 s44, 3
    s_cselect_b32 s53, 1, 0
    s_or_b32 s12, s12, s53
    s_add_u32 s44, s44, 1
    s_cmp_eq_u32 s44, 7
    s_cselect_b32 s44, 0, s44
    s_cselect_b32 s53, 0x40000, 0
    s_add_u32 s45, s45, s53
    s_lshr_b32 s53, s44, 2
    s_lshl_b32 s53, s53, 17
    s_and_b32 s54, s44, 3
    s_lshl_b32 s54, s54, 9
    s_add_u32 s53, s53, s54
    s_add_u32 s5, s53, s45
    s_cmp_eq_u32 s44, 3
    s_cselect_b32 s53, 2, 0
    s_or_b32 s12, s12, s53
    s_add_u32 s44, s44, 1
    s_cmp_eq_u32 s44, 7
    s_cselect_b32 s44, 0, s44
    s_cselect_b32 s53, 0x40000, 0
    s_add_u32 s45, s45, s53
    s_lshr_b32 s53, s44, 2
    s_lshl_b32 s53, s53, 17
    s_and_b32 s54, s44, 3
    s_lshl_b32 s54, s54, 9
    s_add_u32 s53, s53, s54
    s_add_u32 s6, s53, s45
    s_cmp_eq_u32 s44, 3
    s_cselect_b32 s53, 4, 0
    s_or_b32 s12, s12, s53
    s_add_u32 s44, s44, 1
    s_cmp_eq_u32 s44, 7
    s_cselect_b32 s44, 0, s44
    s_cselect_b32 s53, 0x40000, 0
    s_add_u32 s45, s45, s53
    s_lshr_b32 s53, s44, 2
    s_lshl_b32 s53, s53, 17
    s_and_b32 s54, s44, 3
    s_lshl_b32 s54, s54, 9
    s_add_u32 s53, s53, s54
    s_add_u32 s7, s53, s45
    s_cmp_eq_u32 s44, 3
    s_cselect_b32 s53, 8, 0
    s_or_b32 s12, s12, s53
    s_add_u32 s44, s44, 1
    s_cmp_eq_u32 s44, 7
    s_cselect_b32 s44, 0, s44
    s_cselect_b32 s53, 0x40000, 0
    s_add_u32 s45, s45, s53
    s_lshr_b32 s53, s44, 2
    s_lshl_b32 s53, s53, 17
    s_and_b32 s54, s44, 3
    s_lshl_b32 s54, s54, 9
    s_add_u32 s53, s53, s54
    s_add_u32 s8, s53, s45
    s_cmp_eq_u32 s44, 3
    s_cselect_b32 s53, 16, 0
    s_or_b32 s12, s12, s53
    s_add_u32 s44, s44, 1
    s_cmp_eq_u32 s44, 7
    s_cselect_b32 s44, 0, s44
    s_cselect_b32 s53, 0x40000, 0
    s_add_u32 s45, s45, s53
    s_lshr_b32 s53, s44, 2
    s_lshl_b32 s53, s53, 17
    s_and_b32 s54, s44, 3
    s_lshl_b32 s54, s54, 9
    s_add_u32 s53, s53, s54
    s_add_u32 s9, s53, s45
    s_cmp_eq_u32 s44, 3
    s_cselect_b32 s53, 32, 0
    s_or_b32 s12, s12, s53
    s_add_u32 s44, s44, 1
    s_cmp_eq_u32 s44, 7
    s_cselect_b32 s44, 0, s44
    s_cselect_b32 s53, 0x40000, 0
    s_add_u32 s45, s45, s53
    s_lshr_b32 s53, s44, 2
    s_lshl_b32 s53, s53, 17
    s_and_b32 s54, s44, 3
    s_lshl_b32 s54, s54, 9
    s_add_u32 s53, s53, s54
    s_add_u32 s10, s53, s45
    s_cmp_eq_u32 s44, 3
    s_cselect_b32 s53, 64, 0
    s_or_b32 s12, s12, s53
    s_add_u32 s44, s44, 1
    s_cmp_eq_u32 s44, 7
    s_cselect_b32 s44, 0, s44
    s_cselect_b32 s53, 0x40000, 0
    s_add_u32 s45, s45, s53
    s_lshr_b32 s53, s44, 2
    s_lshl_b32 s53, s53, 17
    s_and_b32 s54, s44, 3
    s_lshl_b32 s54, s54, 9
    s_add_u32 s53, s53, s54
    s_add_u32 s11, s53, s45
    s_cmp_eq_u32 s44, 3
    s_cselect_b32 s53, 128, 0
    s_or_b32 s12, s12, s53
    s_waitcnt vmcnt(0)
    v_readfirstlane_b32 s62, v243
    s_nop 0
    s_mul_i32 s62, s62, 1664525
    s_add_u32 s62, s62, 1013904223
    s_mul_i32 s63, s62, 0x9E3779B1
    s_xor_b32 s63, s63, 0x5bd1e995
    s_mov_b32 s61, 0
    s_barrier
    ds_read_b128 v[112:115], v20
    ds_read_b64_tr_b16 v[64:65], v24 offset:0
    ds_read_b64_tr_b16 v[66:67], v24 offset:768
    ds_read_b64_tr_b16 v[68:69], v24 offset:64
    ds_read_b64_tr_b16 v[70:71], v24 offset:832
    ds_read_b64_tr_b16 v[72:73], v24 offset:128
    ds_read_b64_tr_b16 v[74:75], v24 offset:896
    ds_read_b128 v[116:119], v21
    ds_read_b64_tr_b16 v[76:77], v25 offset:0
    ds_read_b64_tr_b16 v[78:79], v25 offset:768
    ds_read_b64_tr_b16 v[80:81], v25 offset:64
    ds_read_b64_tr_b16 v[82:83], v25 offset:832
    ds_read_b64_tr_b16 v[84:85], v25 offset:128
    ds_read_b64_tr_b16 v[86:87], v25 offset:896
A_P1:
    s_waitcnt lgkmcnt(7)
    v_mfma_f32_32x32x16_bf16 v[128:143], v[64:67], v[112:115], v[128:143]
    ds_read_b128 v[120:123], v22
    ds_read_b64_tr_b16 v[88:89], v26 offset:0
    v_mfma_f32_16x16x32_bf16 v[176:179], v[188:191], v[64:67], v[176:179]
    ds_read_b64_tr_b16 v[90:91], v26 offset:768
    v_mfma_f32_32x32x16_bf16 v[144:159], v[68:71], v[112:115], v[144:159]
    ds_read_b64_tr_b16 v[92:93], v26 offset:64
    v_mfma_f32_16x16x32_bf16 v[180:183], v[188:191], v[68:71], v[180:183]
    ds_read_b64_tr_b16 v[94:95], v26 offset:832
    v_mfma_f32_32x32x16_bf16 v[160:175], v[112:115], v[72:75], v[160:175]
    ds_read_b64_tr_b16 v[96:97], v26 offset:128
    v_mfma_f32_16x16x32_bf16 v[184:187], v[188:191], v[72:75], v[184:187]
    ds_read_b64_tr_b16 v[98:99], v26 offset:896
    s_waitcnt lgkmcnt(7)
    v_mfma_f32_32x32x16_bf16 v[128:143], v[76:79], v[116:119], v[128:143]
    ds_read_b128 v[124:127], v23
    ds_read_b64_tr_b16 v[100:101], v27 offset:0
    ds_read_b64_tr_b16 v[102:103], v27 offset:768
    ds_read_b64_tr_b16 v[104:105], v27 offset:64
    v_mfma_f32_32x32x16_bf16 v[144:159], v[80:83], v[116:119], v[144:159]
    ds_read_b64_tr_b16 v[106:107], v27 offset:832
    ds_read_b64_tr_b16 v[108:109], v27 offset:128
    ds_read_b64_tr_b16 v[110:111], v27 offset:896
    s_add_u32 s61, s61, 1
    v_mfma_f32_32x32x16_bf16 v[160:175], v[116:119], v[84:87], v[160:175]
    s_and_b32 s53, s61, 3
    s_cmp_eq_u32 s53, 0
    s_mov_b32 s53, 12288
    s_cselect_b32 s53, -36864, s53
    s_waitcnt lgkmcnt(7)
    v_mfma_f32_32x32x16_bf16 v[128:143], v[88:91], v[120:123], v[128:143]
    v_add_u32 v24, s53, v24
    v_add_u32 v25, s53, v25
    v_add_u32 v26, s53, v26
    v_add_u32 v27, s53, v27
    v_add_u32 v20, 0x4000, v20
    v_add_u32 v21, 0x4000, v21
    v_mfma_f32_32x32x16_bf16 v[144:159], v[92:95], v[120:123], v[144:159]
    s_cmp_eq_u32 s61, 7
    s_cbranch_scc1 A_P1_END
    s_waitcnt lgkmcnt(0)
    s_barrier
    v_mfma_f32_32x32x16_bf16 v[160:175], v[120:123], v[96:99], v[160:175]
    ds_read_b128 v[112:115], v20
    ds_read_b64_tr_b16 v[64:65], v24 offset:0
    ds_read_b64_tr_b16 v[66:67], v24 offset:768
    ds_read_b64_tr_b16 v[68:69], v24 offset:64
    ds_read_b64_tr_b16 v[70:71], v24 offset:832
    ds_read_b64_tr_b16 v[72:73], v24 offset:128
    ds_read_b64_tr_b16 v[74:75], v24 offset:896
    v_add_u32 v22, 0x4000, v22
    v_add_u32 v23, 0x4000, v23
    v_mfma_f32_32x32x16_bf16 v[128:143], v[100:103], v[124:127], v[128:143]
    ds_read_b128 v[116:119], v21
    ds_read_b64_tr_b16 v[76:77], v25 offset:0
    ds_read_b64_tr_b16 v[78:79], v25 offset:768
    v_mfma_f32_32x32x16_bf16 v[144:159], v[104:107], v[124:127], v[144:159]
    ds_read_b64_tr_b16 v[80:81], v25 offset:64
    ds_read_b64_tr_b16 v[82:83], v25 offset:832
    v_mfma_f32_32x32x16_bf16 v[160:175], v[124:127], v[108:111], v[160:175]
    ds_read_b64_tr_b16 v[84:85], v25 offset:128
    ds_read_b64_tr_b16 v[86:87], v25 offset:896
    s_branch A_P1
A_P1_END:
    v_cvt_pk_bf16_f32 v177, v176, v176
    v_and_b32 v177, 0xffff0000, v177
    v_sub_f32 v176, v176, v177
    v_cvt_pk_bf16_f32 v176, v177, v176
    ds_write_b32 v31, v176 offset:0
    v_cvt_pk_bf16_f32 v181, v180, v180
    v_and_b32 v181, 0xffff0000, v181
    v_sub_f32 v180, v180, v181
    v_cvt_pk_bf16_f32 v180, v181, v180
    ds_write_b32 v31, v180 offset:1024
    v_mfma_f32_32x32x16_bf16 v[160:175], v[120:123], v[96:99], v[160:175]
    v_cvt_pk_bf16_f32 v185, v184, v184
    v_and_b32 v185, 0xffff0000, v185
    v_sub_f32 v184, v184, v185
    v_cvt_pk_bf16_f32 v184, v185, v184
    ds_write_b32 v31, v184 offset:2048
    v_and_b32 v3, -16, v31
    s_waitcnt lgkmcnt(0)
    v_mfma_f32_32x32x16_bf16 v[128:143], v[100:103], v[124:127], v[128:143]
    s_barrier
    ds_read_b32 v76, v202
    ds_read_b128 v[64:67], v3 offset:0
    ds_read_b128 v[68:71], v3 offset:1024
    ds_read_b128 v[72:75], v3 offset:2048
    ds_read_b32 v10, v200
    v_mfma_f32_32x32x16_bf16 v[144:159], v[104:107], v[124:127], v[144:159]
    ds_read_b128 v[80:83], v201 offset:0
    ds_read_b128 v[84:87], v201 offset:32
    ds_read_b128 v[88:91], v201 offset:64
    ds_read_b128 v[92:95], v201 offset:96
    v_mfma_f32_32x32x16_bf16 v[160:175], v[124:127], v[108:111], v[160:175]
    s_waitcnt lgkmcnt(8)
    v_mov_b32 v77, v76
    v_mov_b32 v78, v76
    v_mov_b32 v79, v76
    s_waitcnt lgkmcnt(4)
    s_nop 0
    v_mfma_f32_32x32x16_bf16 v[128:143], v[64:67], v[76:79], v[128:143]
    v_mfma_f32_32x32x16_bf16 v[144:159], v[68:71], v[76:79], v[144:159]
    v_mfma_f32_32x32x16_bf16 v[160:175], v[76:79], v[72:75], v[160:175]
    v_mul_f32 v11, s58, v10
    s_nop 8
    v_mul_f32 v128, v11, v128
    v_mul_f32 v129, v11, v129
    v_mul_f32 v130, v11, v130
    v_mul_f32 v131, v11, v131
    s_bitcmp1_b32 s12, 0
    v_cvt_pk_bf16_f32 v128, v128, v129
    v_cvt_pk_bf16_f32 v129, v130, v131
    s_cbranch_scc1 A_SPC0
    buffer_store_dwordx2 v[128:129], v28, s[36:39], s4 offen sc1
A_SPR0:
    v_mul_f32 v132, v11, v132
    v_mul_f32 v133, v11, v133
    v_mul_f32 v134, v11, v134
    v_mul_f32 v135, v11, v135
    s_bitcmp1_b32 s12, 1
    v_cvt_pk_bf16_f32 v132, v132, v133
    v_cvt_pk_bf16_f32 v133, v134, v135
    s_cbranch_scc1 A_SPC1
    buffer_store_dwordx2 v[132:133], v28, s[36:39], s5 offen sc1
A_SPR1:
    v_mul_f32 v136, v11, v136
    v_mul_f32 v137, v11, v137
    v_mul_f32 v138, v11, v138
    v_mul_f32 v139, v11, v139
    s_bitcmp1_b32 s12, 2
    v_cvt_pk_bf16_f32 v136, v136, v137
    v_cvt_pk_bf16_f32 v137, v138, v139
    s_cbranch_scc1 A_SPC2
    buffer_store_dwordx2 v[136:137], v28, s[36:39], s6 offen sc1
A_SPR2:
    v_mul_f32 v140, v11, v140
    v_mul_f32 v141, v11, v141
    v_mul_f32 v142, v11, v142
    v_mul_f32 v143, v11, v143
    s_bitcmp1_b32 s12, 3
    v_cvt_pk_bf16_f32 v140, v140, v141
    v_cvt_pk_bf16_f32 v141, v142, v143
    s_cbranch_scc1 A_SPC3
    buffer_store_dwordx2 v[140:141], v28, s[36:39], s7 offen sc1
A_SPR3:
    v_mul_f32 v144, v11, v144
    v_mul_f32 v145, v11, v145
    v_mul_f32 v146, v11, v146
    v_mul_f32 v147, v11, v147
    s_bitcmp1_b32 s12, 4
    v_cvt_pk_bf16_f32 v144, v144, v145
    v_cvt_pk_bf16_f32 v145, v146, v147
    s_cbranch_scc1 A_SPC4
    buffer_store_dwordx2 v[144:145], v28, s[36:39], s8 offen sc1
A_SPR4:
    v_mul_f32 v148, v11, v148
    v_mul_f32 v149, v11, v149
    v_mul_f32 v150, v11, v150
    v_mul_f32 v151, v11, v151
    s_bitcmp1_b32 s12, 5
    v_cvt_pk_bf16_f32 v148, v148, v149
    v_cvt_pk_bf16_f32 v149, v150, v151
    s_cbranch_scc1 A_SPC5
    buffer_store_dwordx2 v[148:149], v28, s[36:39], s9 offen sc1
A_SPR5:
    v_mul_f32 v152, v11, v152
    v_mul_f32 v153, v11, v153
    v_mul_f32 v154, v11, v154
    v_mul_f32 v155, v11, v155
    s_bitcmp1_b32 s12, 6
    v_cvt_pk_bf16_f32 v152, v152, v153
    v_cvt_pk_bf16_f32 v153, v154, v155
    s_cbranch_scc1 A_SPC6
    buffer_store_dwordx2 v[152:153], v28, s[36:39], s10 offen sc1
A_SPR6:
    v_mul_f32 v156, v11, v156
    v_mul_f32 v157, v11, v157
    v_mul_f32 v158, v11, v158
    v_mul_f32 v159, v11, v159
    s_bitcmp1_b32 s12, 7
    v_cvt_pk_bf16_f32 v156, v156, v157
    v_cvt_pk_bf16_f32 v157, v158, v159
    s_cbranch_scc1 A_SPC7
    buffer_store_dwordx2 v[156:157], v28, s[36:39], s11 offen sc1
A_SPR7:
    s_waitcnt lgkmcnt(0)
    v_mul_f32 v160, v80, v160
    v_mul_f32 v161, v81, v161
    v_mul_f32 v162, v82, v162
    v_mul_f32 v163, v83, v163
    v_mul_f32 v164, v84, v164
    v_mul_f32 v165, v85, v165
    v_mul_f32 v166, v86, v166
    v_mul_f32 v167, v87, v167
    v_cvt_pk_bf16_f32 v160, v160, v161
    v_cvt_pk_bf16_f32 v161, v162, v163
    v_cvt_pk_bf16_f32 v162, v164, v165
    v_cvt_pk_bf16_f32 v163, v166, v167
    buffer_store_dwordx4 v[160:163], v30, s[36:39], 0 offen offset:0 sc1
    v_mul_f32 v168, v88, v168
    v_mul_f32 v169, v89, v169
    v_mul_f32 v170, v90, v170
    v_mul_f32 v171, v91, v171
    v_mul_f32 v172, v92, v172
    v_mul_f32 v173, v93, v173
    v_mul_f32 v174, v94, v174
    v_mul_f32 v175, v95, v175
    v_cvt_pk_bf16_f32 v168, v168, v169
    v_cvt_pk_bf16_f32 v169, v170, v171
    v_cvt_pk_bf16_f32 v170, v172, v173
    v_cvt_pk_bf16_f32 v171, v174, v175
    buffer_store_dwordx4 v[168:171], v30, s[36:39], 0 offen offset:1024 sc1
    s_mov_b32 s46, 3
ATT:
    s_and_b32 s50, s2, 15
    s_lshr_b32 s51, s2, 4
    s_mul_i32 s53, s50, 7
    v_bfe_u32 v3, v0, 2, 1
    v_mul_u32_u24 v3, 6, v3
    v_add_u32 v3, s53, v3
    v_lshrrev_b32 v4, 4, v3
    v_lshrrev_b32 v5, 3, v3
    v_add_u32 v6, 7, v4
    v_cmp_gt_u32 vcc, 8, v0
    s_lshl_b32 s53, s49, 2
    v_and_b32 v7, 3, v0
    v_cndmask_b32 v5, v5, v6, vcc
    v_add_u32 v7, s53, v7
    v_cmp_gt_u32 vcc, 16, v0
    v_mov_b32 v6, s51
    v_mov_b32 v8, s53
    v_cndmask_b32 v5, v4, v5, vcc
    v_cndmask_b32 v7, v6, v7, vcc
    v_cndmask_b32 v8, v6, v8, vcc
    v_cmp_le_u32 vcc, 7, v5
    v_lshlrev_b32 v232, 5, v5
    v_add_u32 v4, -220, v232
    v_cndmask_b32 v232, v232, v4, vcc
    v_and_b32 v4, 3, v7
    v_lshl_add_u32 v232, v4, 3, v232
    v_lshrrev_b32 v4, 2, v7
    v_add_u32 v232, v232, v4
    v_lshlrev_b32 v232, 7, v232
    v_add_u32 v232, 18874368, v232
    v_cmp_le_u32 vcc, 7, v5
    v_lshlrev_b32 v234, 5, v5
    v_add_u32 v4, -220, v234
    v_cndmask_b32 v234, v234, v4, vcc
    v_and_b32 v4, 3, v8
    v_lshl_add_u32 v234, v4, 3, v234
    v_lshrrev_b32 v4, 2, v8
    v_add_u32 v234, v234, v4
    v_lshlrev_b32 v234, 7, v234
    v_add_u32 v234, 18874368, v234
    s_and_b32 s53, s2, 31
    s_lshl_b32 s53, s53, 7
    s_add_u32 s53, s53, 18903040
    s_mov_b64 exec, s[22:23]
    v_mov_b32 v234, s53
    s_mov_b64 exec, -1
    s_lshl_b32 s53, s50, 17
    s_lshl_b32 s54, s51, 13
    s_add_u32 s54, s53, s54
    v_lshl_add_u32 v233, v0, 4, s54
    s_lshl_b32 s54, s49, 15
    s_add_u32 s53, s53, s54
    s_add_u32 s53, s53, 2097152
    v_lshl_add_u32 v12, v0, 4, s53
    s_mov_b32 s24, s20
    s_mov_b32 s25, s21
    s_mov_b32 s26, 268435456
    s_mov_b32 s27, 0x00020000
    s_add_u32 s26, s53, 32768
    s_mul_i32 s53, s50, 28
    v_add_u32 v3, s53, v1
    v_lshrrev_b32 v4, 5, v3
    v_and_b32 v3, 31, v3
    v_lshlrev_b32 v3, 4, v3
    v_lshl_add_u32 v3, v4, 11, v3
    v_lshl_add_u32 v3, v2, 9, v3
    s_mul_i32 s53, s49, 458752
    s_add_u32 s53, s53, 20971520
    v_add_u32 v3, s53, v3
    v_cmp_gt_u32 vcc, 28, v1
    v_mov_b32 v4, s47
    v_mov_b32 v5, 28672
    v_cndmask_b32 v14, v4, v3, vcc
    v_cndmask_b32 v15, 0, v5, vcc
    s_mov_b32 s28, s20
    s_mov_b32 s29, s21
    s_mov_b32 s30, 268435456
    s_mov_b32 s31, 0x00020000
    s_add_u32 s30, s53, 458752
    v_lshlrev_b32 v8, 3, v1
    v_add_u32 v8, 157696, v8
    v_lshlrev_b32 v9, 4, v0
    s_add_u32 s53, s49, 1
    s_and_b32 s53, s53, 3
    s_lshl_b32 s4, s53, 11
    s_lshl_b32 s54, s53, 8
    v_add_u32 v228, s54, v8
    s_mul_i32 s54, s53, 12288
    v_add_u32 v224, s54, v9
    s_add_u32 s53, s49, 2
    s_and_b32 s53, s53, 3
    s_lshl_b32 s5, s53, 11
    s_lshl_b32 s54, s53, 8
    v_add_u32 v229, s54, v8
    s_mul_i32 s54, s53, 12288
    s_add_u32 s54, s54, 4096
    v_add_u32 v225, s54, v9
    s_add_u32 s53, s49, 3
    s_and_b32 s53, s53, 3
    s_lshl_b32 s6, s53, 11
    s_lshl_b32 s54, s53, 8
    v_add_u32 v230, s54, v8
    s_mul_i32 s54, s53, 12288
    s_add_u32 s54, s54, 8192
    v_add_u32 v226, s54, v9
    s_add_u32 s53, s49, 4
    s_and_b32 s53, s53, 3
    s_lshl_b32 s7, s53, 11
    s_lshl_b32 s54, s53, 8
    v_add_u32 v231, s54, v8
    s_mul_i32 s54, s53, 12288
    v_add_u32 v227, s54, v9
    v_mov_b32 v3, 158720
    v_mov_b32 v4, 1
    s_lshl_b32 s55, s2, 7
    s_add_u32 s55, s55, 18874368
    s_waitcnt vmcnt(0)
    s_mov_b64 exec, 1
    ds_add_rtn_u32 v5, v3, v4
    s_mov_b64 exec, -1
    s_waitcnt lgkmcnt(0)
    v_readfirstlane_b32 s53, v5
    s_nop 0
    s_cmp_lg_u32 s53, s46
    s_cbranch_scc1 A_NOFLAG
    v_lshl_add_u32 v242, v0, 3, s55
    v_mov_b32 v240, s62
    v_mov_b32 v241, s63
    s_mov_b64 exec, 0xffff
    buffer_store_dwordx2 v[240:241], v242, s[36:39], 0 offen sc1
    s_mov_b64 exec, -1
A_NOFLAG:
    s_cmp_ge_u32 s2, 224
    s_cbranch_scc1 A_NOAQ
    s_add_u32 m0, s41, 0
    s_mov_b32 s56, 0
    buffer_load_dwordx4 v249, s[32:35], s56 offen offset:0 lds
    s_mov_b32 s56, 6144
    buffer_load_dwordx4 v249, s[32:35], s56 offen offset:1024 lds
    s_mov_b32 s56, 12288
    buffer_load_dwordx4 v249, s[32:35], s56 offen offset:2048 lds
    s_mov_b32 s56, 18432
    buffer_load_dwordx4 v249, s[32:35], s56 offen offset:3072 lds
    s_add_u32 m0, s41, 4096
    s_mov_b32 s56, 28672
    buffer_load_dwordx4 v249, s[32:35], s56 offen offset:0 lds
    s_mov_b32 s56, 34816
    buffer_load_dwordx4 v249, s[32:35], s56 offen offset:1024 lds
    s_mov_b32 s56, 40960
    buffer_load_dwordx4 v249, s[32:35], s56 offen offset:2048 lds
    s_mov_b32 s56, 47104
    buffer_load_dwordx4 v249, s[32:35], s56 offen offset:3072 lds
A_NOAQ:
    s_and_b32 s53, s2, 3
    s_lshl_b32 s53, s53, 3
    s_and_b32 s54, s2, 4
    s_add_u32 s53, s53, s54
    s_bfe_u32 s54, s2, 0x20003
    s_add_u32 s53, s53, s54
    s_lshl_b32 s53, s53, 1
    s_lshr_b32 s54, s49, 1
    s_add_u32 s53, s53, s54
    s_mul_i32 s53, s53, 147456
    s_and_b32 s55, s49, 1
    s_lshl_b32 s54, s55, 14
    s_add_u32 s53, s53, s54
    s_add_u32 s53, s53, 6406144
    v_add_u32 v247, s53, v9
    v_bfe_u32 v3, v0, 2, 2
    v_lshl_add_u32 v4, v2, 2, v3
    v_lshlrev_b32 v4, 7, v4
    v_lshrrev_b32 v3, 1, v3
    v_xor_b32 v3, s55, v3
    v_lshl_add_u32 v4, v3, 6, v4
    v_and_b32 v3, 1, v0
    v_lshl_add_u32 v4, v3, 5, v4
    v_bfe_u32 v3, v0, 4, 1
    v_lshl_add_u32 v4, v3, 4, v4
    v_bfe_u32 v3, v0, 1, 1
    v_lshl_add_u32 v4, v3, 3, v4
    s_mul_i32 s53, s55, 29696
    s_add_u32 s53, s53, 49152
    v_add_u32 v248, s53, v4
    v_mov_b32 v64, 0
    v_mov_b32 v65, 0
    v_mov_b32 v66, 0
    v_mov_b32 v67, 0
    v_mov_b32 v68, 0
    v_mov_b32 v69, 0
    v_mov_b32 v70, 0
    v_mov_b32 v71, 0
    v_mov_b32 v72, 0
    v_mov_b32 v73, 0
    v_mov_b32 v74, 0
    v_mov_b32 v75, 0
    v_mov_b32 v76, 0
    v_mov_b32 v77, 0
    v_mov_b32 v78, 0
    v_mov_b32 v79, 0
    v_mov_b32 v80, 0
    v_mov_b32 v81, 0
    v_mov_b32 v82, 0
    v_mov_b32 v83, 0
    v_mov_b32 v84, 0
    v_mov_b32 v85, 0
    v_mov_b32 v86, 0
    v_mov_b32 v87, 0
    v_mov_b32 v88, 0
    v_mov_b32 v89, 0
    v_mov_b32 v90, 0
    v_mov_b32 v91, 0
    v_mov_b32 v92, 0
    v_mov_b32 v93, 0
    v_mov_b32 v94, 0
    v_mov_b32 v95, 0
    v_mov_b32 v96, 0
    v_mov_b32 v97, 0
    v_mov_b32 v98, 0
    v_mov_b32 v99, 0
    v_mov_b32 v100, 0
    v_mov_b32 v101, 0
    v_mov_b32 v102, 0
    v_mov_b32 v103, 0
    v_mov_b32 v104, 0
    v_mov_b32 v105, 0
    v_mov_b32 v106, 0
    v_mov_b32 v107, 0
    v_mov_b32 v108, 0
    v_mov_b32 v109, 0
    v_mov_b32 v110, 0
    v_mov_b32 v111, 0
    v_mov_b32 v112, 0
    v_mov_b32 v113, 0
    v_mov_b32 v114, 0
    v_mov_b32 v115, 0
    v_mov_b32 v116, 0
    v_mov_b32 v117, 0
    v_mov_b32 v118, 0
    v_mov_b32 v119, 0
    v_mov_b32 v120, 0
    v_mov_b32 v121, 0
    v_mov_b32 v122, 0
    v_mov_b32 v123, 0
    v_mov_b32 v124, 0
    v_mov_b32 v125, 0
    v_mov_b32 v126, 0
    v_mov_b32 v127, 0
    v_mov_b32 v56, 0
    v_mov_b32 v57, 0
    v_mov_b32 v58, 0
    v_mov_b32 v59, 0
    v_mov_b32 v60, 0
    v_mov_b32 v61, 0
    v_mov_b32 v62, 0
    v_mov_b32 v63, 0
    v_mov_b32 v168, 0
    v_mov_b32 v169, 0
    v_mov_b32 v170, 0
    v_mov_b32 v171, 0
    v_mov_b32 v172, 0
    v_mov_b32 v173, 0
    v_mov_b32 v174, 0
    v_mov_b32 v175, 0
    s_lshl_b32 s53, s49, 2
    s_add_u32 s53, s53, 158832
    v_mov_b32 v246, s53
    v_readlane_b32 s53, v234, 16
    s_nop 1
    v_mov_b32 v3, s53
    s_cmp_lt_u32 s2, 224
    s_cbranch_scc1 A_NOPQ
    s_mov_b32 s61, 40000
PL_27:
    buffer_load_dwordx2 v[10:11], v3, s[36:39], 0 offen sc1
    s_waitcnt vmcnt(0)
    v_cmp_ne_u64 vcc, s[62:63], v[10:11]
    s_cbranch_vccz PLD_28
    s_sleep 4
    s_sub_u32 s61, s61, 1
    s_cmp_lg_u32 s61, 0
    s_cbranch_scc1 PL_27
PLD_28:
A_NOPQ:
    s_mov_b32 s61, 40000
PL_30:
    buffer_load_dwordx2 v[10:11], v234, s[36:39], 0 offen sc1
    s_waitcnt vmcnt(0)
    v_cmp_ne_u64 vcc, s[62:63], v[10:11]
    s_cbranch_vccz PLD_31
    s_sub_u32 s61, s61, 1
    s_cmp_lg_u32 s61, 0
    s_cbranch_scc1 PL_30
PLD_31:
    buffer_load_dwordx4 v[152:155], v233, s[36:39], s7 offen offset:0 sc1
    buffer_load_dwordx4 v[156:159], v233, s[36:39], s7 offen offset:1024 sc1
    buffer_load_dwordx4 v[176:179], v12, s[24:27], 0 offen offset:0 sc1
    buffer_load_dwordx4 v[180:183], v12, s[24:27], 0 offen offset:1024 sc1
    buffer_load_dwordx4 v[128:131], v233, s[36:39], s4 offen offset:0 sc1
    buffer_load_dwordx4 v[132:135], v233, s[36:39], s4 offen offset:1024 sc1
    buffer_load_dwordx4 v[136:139], v233, s[36:39], s5 offen offset:0 sc1
    buffer_load_dwordx4 v[140:143], v233, s[36:39], s5 offen offset:1024 sc1
    buffer_load_dwordx4 v[144:147], v233, s[36:39], s6 offen offset:0 sc1
    buffer_load_dwordx4 v[148:151], v233, s[36:39], s6 offen offset:1024 sc1
    buffer_load_dwordx2 v[240:241], v232, s[36:39], 0 offen sc1
    buffer_load_dwordx4 v[184:187], v14, s[28:31], 0 offen offset:0 sc1
    buffer_load_dwordx4 v[188:191], v14, s[28:31], 0 offen offset:1024 sc1
    v_add_u32 v14, v15, v14
    buffer_load_dwordx4 v[192:195], v12, s[24:27], 0 offen offset:2048 sc1
    buffer_load_dwordx4 v[196:199], v12, s[24:27], 0 offen offset:3072 sc1
    buffer_load_dwordx4 v[200:203], v14, s[28:31], 0 offen offset:0 sc1
    buffer_load_dwordx4 v[204:207], v14, s[28:31], 0 offen offset:1024 sc1
    v_add_u32 v14, v15, v14
    v_add_u32 v12, 4096, v12
    buffer_load_dwordx4 v[208:211], v12, s[24:27], 0 offen offset:0 sc1
    buffer_load_dwordx4 v[212:215], v12, s[24:27], 0 offen offset:1024 sc1
    buffer_load_dwordx4 v[216:219], v14, s[28:31], 0 offen offset:0 sc1
    buffer_load_dwordx4 v[220:223], v14, s[28:31], 0 offen offset:1024 sc1
    v_add_u32 v14, v15, v14
    s_waitcnt vmcnt(19)
    s_mov_b64 exec, s[22:23]
    v_mov_b32 v158, 0
    v_mov_b32 v159, 0
    s_mov_b64 exec, -1
    s_waitcnt vmcnt(17)
    v_mfma_f32_32x32x16_bf16 v[16:31], v[176:179], v[152:155], 0
    v_mfma_f32_32x32x16_bf16 v[16:31], v[180:183], v[156:159], v[16:31]
    s_nop 11
    v_max3_f32 v3, v16, v17, v18
    v_max3_f32 v3, v3, v19, v20
    v_max3_f32 v3, v3, v21, v22
    v_max3_f32 v3, v3, v23, v24
    v_max3_f32 v3, v3, v25, v26
    v_max3_f32 v3, v3, v27, v28
    v_max3_f32 v3, v3, v29, v30
    v_max_f32 v3, v3, v31
    v_mov_b32 v4, v3
    s_nop 1
    v_permlane32_swap_b32 v3, v4
    s_nop 0
    v_max_f32 v3, v3, v4
    v_sub_f32 v3, 0xc2c80000, v3
    v_and_b32 v4, 0xffff0000, v3
    v_sub_f32 v3, v3, v4
    v_and_b32 v5, 0xffff0000, v3
    v_sub_f32 v3, v3, v5
    v_lshrrev_b32 v4, 16, v4
    v_or_b32 v10, v4, v5
    v_lshrrev_b32 v11, 16, v3
    ds_write_b64 v231, v[10:11]
    s_mov_b32 s61, 40000
    s_waitcnt vmcnt(10)
    v_cmp_ne_u64 vcc, s[62:63], v[240:241]
    s_cbranch_vccz PLD_34
PL_33:
    buffer_load_dwordx2 v[240:241], v232, s[36:39], 0 offen sc1
    s_waitcnt vmcnt(0)
    v_cmp_ne_u64 vcc, s[62:63], v[240:241]
    s_cbranch_vccz PLD_34
    s_sub_u32 s61, s61, 1
    s_cmp_lg_u32 s61, 0
    s_cbranch_scc1 PL_33
PLD_34:
    s_mov_b64 exec, s[22:23]
    v_mov_b32 v158, v10
    v_mov_b32 v159, v11
    s_mov_b32 s61, 320000
LS_36:
    ds_read_b64 v[134:135], v228
    ds_read_b64 v[142:143], v229
    ds_read_b64 v[150:151], v230
    s_waitcnt lgkmcnt(0)
    v_cmp_eq_u32 vcc, -1, v135
    v_cmp_eq_u32 s[54:55], -1, v143
    s_or_b64 vcc, vcc, s[54:55]
    v_cmp_eq_u32 s[54:55], -1, v151
    s_or_b64 vcc, vcc, s[54:55]
    s_cbranch_vccz LSD_37
    s_sub_u32 s61, s61, 1
    s_cmp_lg_u32 s61, 0
    s_cbranch_scc1 LS_36
LSD_37:
    s_mov_b64 exec, -1
    v_mfma_f32_32x32x16_bf16 v[16:31], v[176:179], v[128:131], 0
    v_mfma_f32_32x32x16_bf16 v[16:31], v[180:183], v[132:135], v[16:31]
    s_mov_b32 s61, 4
    ds_write_b32 v246, v64
    v_mov_b32 v5, 158736
    s_nop 6
    s_branch ATT_MID
.p2align 6
ATT_LOOP:
    v_mfma_f32_32x32x16_bf16 v[32:47], v[160:163], v[136:139], 0
    buffer_load_dwordx4 v[208:211], v12, s[24:27], 0 offen offset:0 sc1
    v_exp_f32 v16, v16
    v_exp_f32 v17, v17
    v_exp_f32 v18, v18
    v_exp_f32 v19, v19
    v_cvt_pk_bf16_f32 v48, v16, v17
    v_cvt_pk_bf16_f32 v49, v18, v19
    v_mfma_f32_32x32x16_bf16 v[32:47], v[164:167], v[140:143], v[32:47]
    v_exp_f32 v20, v20
    v_exp_f32 v21, v21
    v_exp_f32 v22, v22
    v_exp_f32 v23, v23
    v_cvt_pk_bf16_f32 v50, v20, v21
    v_cvt_pk_bf16_f32 v51, v22, v23
    v_mfma_f32_32x32x16_bf16 v[112:127], v[216:219], v[56:59], v[112:127]
    v_exp_f32 v24, v24
    v_exp_f32 v25, v25
    v_exp_f32 v26, v26
    v_exp_f32 v27, v27
    v_cvt_pk_bf16_f32 v52, v24, v25
    v_cvt_pk_bf16_f32 v53, v26, v27
    v_mfma_f32_32x32x16_bf16 v[112:127], v[220:223], v[60:63], v[112:127]
    v_exp_f32 v28, v28
    v_exp_f32 v29, v29
    v_exp_f32 v30, v30
    v_exp_f32 v31, v31
    v_cvt_pk_bf16_f32 v54, v28, v29
    v_cvt_pk_bf16_f32 v55, v30, v31
    v_mfma_f32_32x32x16_bf16 v[16:31], v[160:163], v[144:147], 0
    buffer_load_dwordx4 v[212:215], v12, s[24:27], 0 offen offset:1024 sc1
    v_exp_f32 v32, v32
    v_exp_f32 v33, v33
    v_exp_f32 v34, v34
    v_exp_f32 v35, v35
    v_cvt_pk_bf16_f32 v56, v32, v33
    v_cvt_pk_bf16_f32 v57, v34, v35
    v_mfma_f32_32x32x16_bf16 v[16:31], v[164:167], v[148:151], v[16:31]
    s_waitcnt vmcnt(10)
    v_exp_f32 v36, v36
    v_exp_f32 v37, v37
    v_exp_f32 v38, v38
    v_exp_f32 v39, v39
    v_cvt_pk_bf16_f32 v58, v36, v37
    v_cvt_pk_bf16_f32 v59, v38, v39
    v_mfma_f32_32x32x16_bf16 v[64:79], v[168:171], v[48:51], v[64:79]
    v_exp_f32 v40, v40
    v_exp_f32 v41, v41
    v_exp_f32 v42, v42
    v_exp_f32 v43, v43
    v_cvt_pk_bf16_f32 v60, v40, v41
    v_cvt_pk_bf16_f32 v61, v42, v43
    v_mfma_f32_32x32x16_bf16 v[64:79], v[172:175], v[52:55], v[64:79]
    v_exp_f32 v44, v44
    v_exp_f32 v45, v45
    v_exp_f32 v46, v46
    v_exp_f32 v47, v47
    v_cvt_pk_bf16_f32 v62, v44, v45
    v_cvt_pk_bf16_f32 v63, v46, v47
    v_mfma_f32_32x32x16_bf16 v[32:47], v[160:163], v[152:155], 0
    buffer_load_dwordx4 v[216:219], v14, s[28:31], 0 offen offset:0 sc1
    v_exp_f32 v16, v16
    v_exp_f32 v17, v17
    v_exp_f32 v18, v18
    v_exp_f32 v19, v19
    v_cvt_pk_bf16_f32 v48, v16, v17
    v_cvt_pk_bf16_f32 v49, v18, v19
    v_mfma_f32_32x32x16_bf16 v[32:47], v[164:167], v[156:159], v[32:47]
    s_waitcnt vmcnt(9)
    v_exp_f32 v20, v20
    v_exp_f32 v21, v21
    v_exp_f32 v22, v22
    v_exp_f32 v23, v23
    v_cvt_pk_bf16_f32 v50, v20, v21
    v_cvt_pk_bf16_f32 v51, v22, v23
    v_mfma_f32_32x32x16_bf16 v[80:95], v[168:171], v[56:59], v[80:95]
    v_exp_f32 v24, v24
    v_exp_f32 v25, v25
    v_exp_f32 v26, v26
    v_exp_f32 v27, v27
    v_cvt_pk_bf16_f32 v52, v24, v25
    v_cvt_pk_bf16_f32 v53, v26, v27
    v_mfma_f32_32x32x16_bf16 v[80:95], v[172:175], v[60:63], v[80:95]
    v_exp_f32 v28, v28
    v_exp_f32 v29, v29
    v_exp_f32 v30, v30
    v_exp_f32 v31, v31
    v_cvt_pk_bf16_f32 v54, v28, v29
    v_cvt_pk_bf16_f32 v55, v30, v31
    v_mfma_f32_32x32x16_bf16 v[16:31], v[176:179], v[128:131], 0
    buffer_load_dwordx4 v[220:223], v14, s[28:31], 0 offen offset:1024 sc1
    v_exp_f32 v32, v32
    v_exp_f32 v33, v33
    v_exp_f32 v34, v34
    v_exp_f32 v35, v35
    v_cvt_pk_bf16_f32 v56, v32, v33
    v_cvt_pk_bf16_f32 v57, v34, v35
    v_mfma_f32_32x32x16_bf16 v[16:31], v[180:183], v[132:135], v[16:31]
    v_exp_f32 v36, v36
    v_exp_f32 v37, v37
    v_exp_f32 v38, v38
    v_exp_f32 v39, v39
    v_cvt_pk_bf16_f32 v58, v36, v37
    v_cvt_pk_bf16_f32 v59, v38, v39
    v_mfma_f32_32x32x16_bf16 v[96:111], v[168:171], v[48:51], v[96:111]
    v_exp_f32 v40, v40
    v_exp_f32 v41, v41
    v_exp_f32 v42, v42
    v_exp_f32 v43, v43
    v_cvt_pk_bf16_f32 v60, v40, v41
    v_cvt_pk_bf16_f32 v61, v42, v43
    v_mfma_f32_32x32x16_bf16 v[96:111], v[172:175], v[52:55], v[96:111]
    v_exp_f32 v44, v44
    v_exp_f32 v45, v45
    v_exp_f32 v46, v46
    v_exp_f32 v47, v47
    v_cvt_pk_bf16_f32 v62, v44, v45
    v_cvt_pk_bf16_f32 v63, v46, v47
    v_add_u32 v14, v15, v14
ATT_MID:
    v_mfma_f32_32x32x16_bf16 v[32:47], v[176:179], v[136:139], 0
    buffer_load_dwordx4 v[160:163], v12, s[24:27], 0 offen offset:2048 sc1
    v_exp_f32 v16, v16
    v_exp_f32 v17, v17
    v_exp_f32 v18, v18
    v_exp_f32 v19, v19
    v_cvt_pk_bf16_f32 v48, v16, v17
    v_cvt_pk_bf16_f32 v49, v18, v19
    v_mfma_f32_32x32x16_bf16 v[32:47], v[180:183], v[140:143], v[32:47]
    v_exp_f32 v20, v20
    v_exp_f32 v21, v21
    v_exp_f32 v22, v22
    v_exp_f32 v23, v23
    v_cvt_pk_bf16_f32 v50, v20, v21
    v_cvt_pk_bf16_f32 v51, v22, v23
    v_mfma_f32_32x32x16_bf16 v[112:127], v[168:171], v[56:59], v[112:127]
    v_exp_f32 v24, v24
    v_exp_f32 v25, v25
    v_exp_f32 v26, v26
    v_exp_f32 v27, v27
    v_cvt_pk_bf16_f32 v52, v24, v25
    v_cvt_pk_bf16_f32 v53, v26, v27
    v_mfma_f32_32x32x16_bf16 v[112:127], v[172:175], v[60:63], v[112:127]
    v_exp_f32 v28, v28
    v_exp_f32 v29, v29
    v_exp_f32 v30, v30
    v_exp_f32 v31, v31
    v_cvt_pk_bf16_f32 v54, v28, v29
    v_cvt_pk_bf16_f32 v55, v30, v31
    v_mfma_f32_32x32x16_bf16 v[16:31], v[176:179], v[144:147], 0
    buffer_load_dwordx4 v[164:167], v12, s[24:27], 0 offen offset:3072 sc1
    v_exp_f32 v32, v32
    v_exp_f32 v33, v33
    v_exp_f32 v34, v34
    v_exp_f32 v35, v35
    v_cvt_pk_bf16_f32 v56, v32, v33
    v_cvt_pk_bf16_f32 v57, v34, v35
    v_mfma_f32_32x32x16_bf16 v[16:31], v[180:183], v[148:151], v[16:31]
    s_waitcnt vmcnt(10)
    v_exp_f32 v36, v36
    v_exp_f32 v37, v37
    v_exp_f32 v38, v38
    v_exp_f32 v39, v39
    v_cvt_pk_bf16_f32 v58, v36, v37
    v_cvt_pk_bf16_f32 v59, v38, v39
    v_mfma_f32_32x32x16_bf16 v[64:79], v[184:187], v[48:51], v[64:79]
    v_exp_f32 v40, v40
    v_exp_f32 v41, v41
    v_exp_f32 v42, v42
    v_exp_f32 v43, v43
    v_cvt_pk_bf16_f32 v60, v40, v41
    v_cvt_pk_bf16_f32 v61, v42, v43
    v_mfma_f32_32x32x16_bf16 v[64:79], v[188:191], v[52:55], v[64:79]
    v_exp_f32 v44, v44
    v_exp_f32 v45, v45
    v_exp_f32 v46, v46
    v_exp_f32 v47, v47
    v_cvt_pk_bf16_f32 v62, v44, v45
    v_cvt_pk_bf16_f32 v63, v46, v47
    v_add_u32 v12, 4096, v12
    v_mfma_f32_32x32x16_bf16 v[32:47], v[176:179], v[152:155], 0
    buffer_load_dwordx4 v[168:171], v14, s[28:31], 0 offen offset:0 sc1
    v_exp_f32 v16, v16
    v_exp_f32 v17, v17
    v_exp_f32 v18, v18
    v_exp_f32 v19, v19
    v_cvt_pk_bf16_f32 v48, v16, v17
    v_cvt_pk_bf16_f32 v49, v18, v19
    v_mfma_f32_32x32x16_bf16 v[32:47], v[180:183], v[156:159], v[32:47]
    s_waitcnt vmcnt(9)
    v_exp_f32 v20, v20
    v_exp_f32 v21, v21
    v_exp_f32 v22, v22
    v_exp_f32 v23, v23
    v_cvt_pk_bf16_f32 v50, v20, v21
    v_cvt_pk_bf16_f32 v51, v22, v23
    v_mfma_f32_32x32x16_bf16 v[80:95], v[184:187], v[56:59], v[80:95]
    v_exp_f32 v24, v24
    v_exp_f32 v25, v25
    v_exp_f32 v26, v26
    v_exp_f32 v27, v27
    v_cvt_pk_bf16_f32 v52, v24, v25
    v_cvt_pk_bf16_f32 v53, v26, v27
    v_mfma_f32_32x32x16_bf16 v[80:95], v[188:191], v[60:63], v[80:95]
    v_exp_f32 v28, v28
    v_exp_f32 v29, v29
    v_exp_f32 v30, v30
    v_exp_f32 v31, v31
    v_cvt_pk_bf16_f32 v54, v28, v29
    v_cvt_pk_bf16_f32 v55, v30, v31
    v_mfma_f32_32x32x16_bf16 v[16:31], v[192:195], v[128:131], 0
    buffer_load_dwordx4 v[172:175], v14, s[28:31], 0 offen offset:1024 sc1
    v_exp_f32 v32, v32
    v_exp_f32 v33, v33
    v_exp_f32 v34, v34
    v_exp_f32 v35, v35
    v_cvt_pk_bf16_f32 v56, v32, v33
    v_cvt_pk_bf16_f32 v57, v34, v35
    v_mfma_f32_32x32x16_bf16 v[16:31], v[196:199], v[132:135], v[16:31]
    v_exp_f32 v36, v36
    v_exp_f32 v37, v37
    v_exp_f32 v38, v38
    v_exp_f32 v39, v39
    v_cvt_pk_bf16_f32 v58, v36, v37
    v_cvt_pk_bf16_f32 v59, v38, v39
    v_mfma_f32_32x32x16_bf16 v[96:111], v[184:187], v[48:51], v[96:111]
    v_exp_f32 v40, v40
    v_exp_f32 v41, v41
    v_exp_f32 v42, v42
    v_exp_f32 v43, v43
    v_cvt_pk_bf16_f32 v60, v40, v41
    v_cvt_pk_bf16_f32 v61, v42, v43
    v_mfma_f32_32x32x16_bf16 v[96:111], v[188:191], v[52:55], v[96:111]
    v_exp_f32 v44, v44
    v_exp_f32 v45, v45
    v_exp_f32 v46, v46
    v_exp_f32 v47, v47
    v_cvt_pk_bf16_f32 v62, v44, v45
    v_cvt_pk_bf16_f32 v63, v46, v47
    v_add_u32 v14, v15, v14
    v_mfma_f32_32x32x16_bf16 v[32:47], v[192:195], v[136:139], 0
    buffer_load_dwordx4 v[176:179], v12, s[24:27], 0 offen offset:0 sc1
    v_exp_f32 v16, v16
    v_exp_f32 v17, v17
    v_exp_f32 v18, v18
    v_exp_f32 v19, v19
    v_cvt_pk_bf16_f32 v48, v16, v17
    v_cvt_pk_bf16_f32 v49, v18, v19
    v_mfma_f32_32x32x16_bf16 v[32:47], v[196:199], v[140:143], v[32:47]
    v_exp_f32 v20, v20
    v_exp_f32 v21, v21
    v_exp_f32 v22, v22
    v_exp_f32 v23, v23
    v_cvt_pk_bf16_f32 v50, v20, v21
    v_cvt_pk_bf16_f32 v51, v22, v23
    v_mfma_f32_32x32x16_bf16 v[112:127], v[184:187], v[56:59], v[112:127]
    v_exp_f32 v24, v24
    v_exp_f32 v25, v25
    v_exp_f32 v26, v26
    v_exp_f32 v27, v27
    v_cvt_pk_bf16_f32 v52, v24, v25
    v_cvt_pk_bf16_f32 v53, v26, v27
    v_mfma_f32_32x32x16_bf16 v[112:127], v[188:191], v[60:63], v[112:127]
    v_exp_f32 v28, v28
    v_exp_f32 v29, v29
    v_exp_f32 v30, v30
    v_exp_f32 v31, v31
    v_cvt_pk_bf16_f32 v54, v28, v29
    v_cvt_pk_bf16_f32 v55, v30, v31
    v_mfma_f32_32x32x16_bf16 v[16:31], v[192:195], v[144:147], 0
    buffer_load_dwordx4 v[180:183], v12, s[24:27], 0 offen offset:1024 sc1
    v_exp_f32 v32, v32
    v_exp_f32 v33, v33
    v_exp_f32 v34, v34
    v_exp_f32 v35, v35
    v_cvt_pk_bf16_f32 v56, v32, v33
    v_cvt_pk_bf16_f32 v57, v34, v35
    v_mfma_f32_32x32x16_bf16 v[16:31], v[196:199], v[148:151], v[16:31]
    s_waitcnt vmcnt(10)
    v_exp_f32 v36, v36
    v_exp_f32 v37, v37
    v_exp_f32 v38, v38
    v_exp_f32 v39, v39
    v_cvt_pk_bf16_f32 v58, v36, v37
    v_cvt_pk_bf16_f32 v59, v38, v39
    v_mfma_f32_32x32x16_bf16 v[64:79], v[200:203], v[48:51], v[64:79]
    v_exp_f32 v40, v40
    v_exp_f32 v41, v41
    v_exp_f32 v42, v42
    v_exp_f32 v43, v43
    v_cvt_pk_bf16_f32 v60, v40, v41
    v_cvt_pk_bf16_f32 v61, v42, v43
    v_mfma_f32_32x32x16_bf16 v[64:79], v[204:207], v[52:55], v[64:79]
    v_exp_f32 v44, v44
    v_exp_f32 v45, v45
    v_exp_f32 v46, v46
    v_exp_f32 v47, v47
    v_cvt_pk_bf16_f32 v62, v44, v45
    v_cvt_pk_bf16_f32 v63, v46, v47
    v_mfma_f32_32x32x16_bf16 v[32:47], v[192:195], v[152:155], 0
    buffer_load_dwordx4 v[184:187], v14, s[28:31], 0 offen offset:0 sc1
    v_exp_f32 v16, v16
    v_exp_f32 v17, v17
    v_exp_f32 v18, v18
    v_exp_f32 v19, v19
    v_cvt_pk_bf16_f32 v48, v16, v17
    v_cvt_pk_bf16_f32 v49, v18, v19
    v_mfma_f32_32x32x16_bf16 v[32:47], v[196:199], v[156:159], v[32:47]
    s_waitcnt vmcnt(9)
    v_exp_f32 v20, v20
    v_exp_f32 v21, v21
    v_exp_f32 v22, v22
    v_exp_f32 v23, v23
    v_cvt_pk_bf16_f32 v50, v20, v21
    v_cvt_pk_bf16_f32 v51, v22, v23
    v_mfma_f32_32x32x16_bf16 v[80:95], v[200:203], v[56:59], v[80:95]
    v_exp_f32 v24, v24
    v_exp_f32 v25, v25
    v_exp_f32 v26, v26
    v_exp_f32 v27, v27
    v_cvt_pk_bf16_f32 v52, v24, v25
    v_cvt_pk_bf16_f32 v53, v26, v27
    v_mfma_f32_32x32x16_bf16 v[80:95], v[204:207], v[60:63], v[80:95]
    v_exp_f32 v28, v28
    v_exp_f32 v29, v29
    v_exp_f32 v30, v30
    v_exp_f32 v31, v31
    v_cvt_pk_bf16_f32 v54, v28, v29
    v_cvt_pk_bf16_f32 v55, v30, v31
    v_mfma_f32_32x32x16_bf16 v[16:31], v[208:211], v[128:131], 0
    buffer_load_dwordx4 v[188:191], v14, s[28:31], 0 offen offset:1024 sc1
    v_exp_f32 v32, v32
    v_exp_f32 v33, v33
    v_exp_f32 v34, v34
    v_exp_f32 v35, v35
    v_cvt_pk_bf16_f32 v56, v32, v33
    v_cvt_pk_bf16_f32 v57, v34, v35
    v_mfma_f32_32x32x16_bf16 v[16:31], v[212:215], v[132:135], v[16:31]
    v_exp_f32 v36, v36
    v_exp_f32 v37, v37
    v_exp_f32 v38, v38
    v_exp_f32 v39, v39
    v_cvt_pk_bf16_f32 v58, v36, v37
    v_cvt_pk_bf16_f32 v59, v38, v39
    v_mfma_f32_32x32x16_bf16 v[96:111], v[200:203], v[48:51], v[96:111]
    v_exp_f32 v40, v40
    v_exp_f32 v41, v41
    v_exp_f32 v42, v42
    v_exp_f32 v43, v43
    v_cvt_pk_bf16_f32 v60, v40, v41
    v_cvt_pk_bf16_f32 v61, v42, v43
    v_mfma_f32_32x32x16_bf16 v[96:111], v[204:207], v[52:55], v[96:111]
    v_exp_f32 v44, v44
    v_exp_f32 v45, v45
    v_exp_f32 v46, v46
    v_exp_f32 v47, v47
    v_cvt_pk_bf16_f32 v62, v44, v45
    v_cvt_pk_bf16_f32 v63, v46, v47
    v_add_u32 v14, v15, v14
    v_mfma_f32_32x32x16_bf16 v[32:47], v[208:211], v[136:139], 0
    buffer_load_dwordx4 v[192:195], v12, s[24:27], 0 offen offset:2048 sc1
    v_exp_f32 v16, v16
    v_exp_f32 v17, v17
    v_exp_f32 v18, v18
    v_exp_f32 v19, v19
    v_cvt_pk_bf16_f32 v48, v16, v17
    v_cvt_pk_bf16_f32 v49, v18, v19
    v_mfma_f32_32x32x16_bf16 v[32:47], v[212:215], v[140:143], v[32:47]
    v_exp_f32 v20, v20
    v_exp_f32 v21, v21
    v_exp_f32 v22, v22
    v_exp_f32 v23, v23
    v_cvt_pk_bf16_f32 v50, v20, v21
    v_cvt_pk_bf16_f32 v51, v22, v23
    v_mfma_f32_32x32x16_bf16 v[112:127], v[200:203], v[56:59], v[112:127]
    v_exp_f32 v24, v24
    v_exp_f32 v25, v25
    v_exp_f32 v26, v26
    v_exp_f32 v27, v27
    v_cvt_pk_bf16_f32 v52, v24, v25
    v_cvt_pk_bf16_f32 v53, v26, v27
    v_mfma_f32_32x32x16_bf16 v[112:127], v[204:207], v[60:63], v[112:127]
    v_exp_f32 v28, v28
    v_exp_f32 v29, v29
    v_exp_f32 v30, v30
    v_exp_f32 v31, v31
    v_cvt_pk_bf16_f32 v54, v28, v29
    v_cvt_pk_bf16_f32 v55, v30, v31
    v_mfma_f32_32x32x16_bf16 v[16:31], v[208:211], v[144:147], 0
    buffer_load_dwordx4 v[196:199], v12, s[24:27], 0 offen offset:3072 sc1
    v_exp_f32 v32, v32
    v_exp_f32 v33, v33
    v_exp_f32 v34, v34
    v_exp_f32 v35, v35
    v_cvt_pk_bf16_f32 v56, v32, v33
    v_cvt_pk_bf16_f32 v57, v34, v35
    v_mfma_f32_32x32x16_bf16 v[16:31], v[212:215], v[148:151], v[16:31]
    s_waitcnt vmcnt(10)
    v_exp_f32 v36, v36
    v_exp_f32 v37, v37
    v_exp_f32 v38, v38
    v_exp_f32 v39, v39
    v_cvt_pk_bf16_f32 v58, v36, v37
    v_cvt_pk_bf16_f32 v59, v38, v39
    v_mfma_f32_32x32x16_bf16 v[64:79], v[216:219], v[48:51], v[64:79]
    v_exp_f32 v40, v40
    v_exp_f32 v41, v41
    v_exp_f32 v42, v42
    v_exp_f32 v43, v43
    v_cvt_pk_bf16_f32 v60, v40, v41
    v_cvt_pk_bf16_f32 v61, v42, v43
    v_mfma_f32_32x32x16_bf16 v[64:79], v[220:223], v[52:55], v[64:79]
    v_exp_f32 v44, v44
    v_exp_f32 v45, v45
    v_exp_f32 v46, v46
    v_exp_f32 v47, v47
    v_cvt_pk_bf16_f32 v62, v44, v45
    v_cvt_pk_bf16_f32 v63, v46, v47
    v_add_u32 v12, 4096, v12
    v_mfma_f32_32x32x16_bf16 v[32:47], v[208:211], v[152:155], 0
    buffer_load_dwordx4 v[200:203], v14, s[28:31], 0 offen offset:0 sc1
    v_exp_f32 v16, v16
    v_exp_f32 v17, v17
    v_exp_f32 v18, v18
    v_exp_f32 v19, v19
    v_cvt_pk_bf16_f32 v48, v16, v17
    v_cvt_pk_bf16_f32 v49, v18, v19
    v_mfma_f32_32x32x16_bf16 v[32:47], v[212:215], v[156:159], v[32:47]
    s_waitcnt vmcnt(9)
    v_exp_f32 v20, v20
    v_exp_f32 v21, v21
    v_exp_f32 v22, v22
    v_exp_f32 v23, v23
    v_cvt_pk_bf16_f32 v50, v20, v21
    v_cvt_pk_bf16_f32 v51, v22, v23
    v_mfma_f32_32x32x16_bf16 v[80:95], v[216:219], v[56:59], v[80:95]
    v_exp_f32 v24, v24
    v_exp_f32 v25, v25
    v_exp_f32 v26, v26
    v_exp_f32 v27, v27
    v_cvt_pk_bf16_f32 v52, v24, v25
    v_cvt_pk_bf16_f32 v53, v26, v27
    v_mfma_f32_32x32x16_bf16 v[80:95], v[220:223], v[60:63], v[80:95]
    v_exp_f32 v28, v28
    v_exp_f32 v29, v29
    v_exp_f32 v30, v30
    v_exp_f32 v31, v31
    v_cvt_pk_bf16_f32 v54, v28, v29
    v_cvt_pk_bf16_f32 v55, v30, v31
    v_mfma_f32_32x32x16_bf16 v[16:31], v[160:163], v[128:131], 0
    buffer_load_dwordx4 v[204:207], v14, s[28:31], 0 offen offset:1024 sc1
    v_exp_f32 v32, v32
    v_exp_f32 v33, v33
    v_exp_f32 v34, v34
    v_exp_f32 v35, v35
    v_cvt_pk_bf16_f32 v56, v32, v33
    v_cvt_pk_bf16_f32 v57, v34, v35
    v_mfma_f32_32x32x16_bf16 v[16:31], v[164:167], v[132:135], v[16:31]
    s_sub_u32 s61, s61, 1
    v_exp_f32 v36, v36
    v_exp_f32 v37, v37
    v_exp_f32 v38, v38
    v_exp_f32 v39, v39
    v_cvt_pk_bf16_f32 v58, v36, v37
    v_cvt_pk_bf16_f32 v59, v38, v39
    v_mfma_f32_32x32x16_bf16 v[96:111], v[216:219], v[48:51], v[96:111]
    s_cmp_lg_u32 s61, 0
    v_exp_f32 v40, v40
    v_exp_f32 v41, v41
    v_exp_f32 v42, v42
    v_exp_f32 v43, v43
    v_cvt_pk_bf16_f32 v60, v40, v41
    v_cvt_pk_bf16_f32 v61, v42, v43
    v_mfma_f32_32x32x16_bf16 v[96:111], v[220:223], v[52:55], v[96:111]
    v_exp_f32 v44, v44
    v_exp_f32 v45, v45
    v_exp_f32 v46, v46
    v_exp_f32 v47, v47
    v_cvt_pk_bf16_f32 v62, v44, v45
    v_cvt_pk_bf16_f32 v63, v46, v47
    v_add_u32 v14, v15, v14
    s_cbranch_scc1 ATT_LOOP
    ds_write_b32 v5, v5 offset:176
    v_mfma_f32_32x32x16_bf16 v[32:47], v[160:163], v[136:139], 0
    ds_read_b128 v[236:239], v5
    v_exp_f32 v16, v16
    v_exp_f32 v17, v17
    v_exp_f32 v18, v18
    v_exp_f32 v19, v19
    v_cvt_pk_bf16_f32 v48, v16, v17
    v_cvt_pk_bf16_f32 v49, v18, v19
    v_mfma_f32_32x32x16_bf16 v[32:47], v[164:167], v[140:143], v[32:47]
    v_exp_f32 v20, v20
    v_exp_f32 v21, v21
    v_exp_f32 v22, v22
    v_exp_f32 v23, v23
    v_cvt_pk_bf16_f32 v50, v20, v21
    v_cvt_pk_bf16_f32 v51, v22, v23
    v_mfma_f32_32x32x16_bf16 v[112:127], v[216:219], v[56:59], v[112:127]
    v_exp_f32 v24, v24
    v_exp_f32 v25, v25
    v_exp_f32 v26, v26
    v_exp_f32 v27, v27
    v_cvt_pk_bf16_f32 v52, v24, v25
    v_cvt_pk_bf16_f32 v53, v26, v27
    v_mfma_f32_32x32x16_bf16 v[112:127], v[220:223], v[60:63], v[112:127]
    v_exp_f32 v28, v28
    v_exp_f32 v29, v29
    v_exp_f32 v30, v30
    v_exp_f32 v31, v31
    v_cvt_pk_bf16_f32 v54, v28, v29
    v_cvt_pk_bf16_f32 v55, v30, v31
    v_mfma_f32_32x32x16_bf16 v[16:31], v[160:163], v[144:147], 0
    v_exp_f32 v32, v32
    v_exp_f32 v33, v33
    v_exp_f32 v34, v34
    v_exp_f32 v35, v35
    v_cvt_pk_bf16_f32 v56, v32, v33
    v_cvt_pk_bf16_f32 v57, v34, v35
    v_mfma_f32_32x32x16_bf16 v[16:31], v[164:167], v[148:151], v[16:31]
    s_waitcnt vmcnt(0) lgkmcnt(0)
    v_exp_f32 v36, v36
    v_exp_f32 v37, v37
    v_exp_f32 v38, v38
    v_exp_f32 v39, v39
    v_cvt_pk_bf16_f32 v58, v36, v37
    v_cvt_pk_bf16_f32 v59, v38, v39
    v_mfma_f32_32x32x16_bf16 v[64:79], v[168:171], v[48:51], v[64:79]
    v_exp_f32 v40, v40
    v_exp_f32 v41, v41
    v_exp_f32 v42, v42
    v_exp_f32 v43, v43
    v_cvt_pk_bf16_f32 v60, v40, v41
    v_cvt_pk_bf16_f32 v61, v42, v43
    v_mfma_f32_32x32x16_bf16 v[64:79], v[172:175], v[52:55], v[64:79]
    v_exp_f32 v44, v44
    v_exp_f32 v45, v45
    v_exp_f32 v46, v46
    v_exp_f32 v47, v47
    v_cvt_pk_bf16_f32 v62, v44, v45
    v_cvt_pk_bf16_f32 v63, v46, v47
    v_or3_b32 v236, v236, v237, v238
    v_or_b32 v236, v236, v239
    v_cmp_ne_u32 vcc, 0, v236
    s_cbranch_vccnz ATT_FWAIT
ATT_FOK:
    v_mfma_f32_32x32x16_bf16 v[32:47], v[160:163], v[152:155], 0
    v_exp_f32 v16, v16
    v_exp_f32 v17, v17
    v_exp_f32 v18, v18
    v_exp_f32 v19, v19
    v_cvt_pk_bf16_f32 v48, v16, v17
    v_cvt_pk_bf16_f32 v49, v18, v19
    v_mfma_f32_32x32x16_bf16 v[32:47], v[164:167], v[156:159], v[32:47]
    ds_write_b128 v224, v[64:67] offset:0
    ds_write_b128 v224, v[68:71] offset:1024
    v_exp_f32 v20, v20
    v_exp_f32 v21, v21
    v_exp_f32 v22, v22
    v_exp_f32 v23, v23
    v_cvt_pk_bf16_f32 v50, v20, v21
    v_cvt_pk_bf16_f32 v51, v22, v23
    v_mfma_f32_32x32x16_bf16 v[80:95], v[168:171], v[56:59], v[80:95]
    ds_write_b128 v224, v[72:75] offset:2048
    v_exp_f32 v24, v24
    v_exp_f32 v25, v25
    v_exp_f32 v26, v26
    v_exp_f32 v27, v27
    v_cvt_pk_bf16_f32 v52, v24, v25
    v_cvt_pk_bf16_f32 v53, v26, v27
    v_mfma_f32_32x32x16_bf16 v[80:95], v[172:175], v[60:63], v[80:95]
    ds_write_b128 v224, v[76:79] offset:3072
    v_exp_f32 v28, v28
    v_exp_f32 v29, v29
    v_exp_f32 v30, v30
    v_exp_f32 v31, v31
    v_cvt_pk_bf16_f32 v54, v28, v29
    v_cvt_pk_bf16_f32 v55, v30, v31
    v_exp_f32 v32, v32
    v_exp_f32 v33, v33
    v_exp_f32 v34, v34
    v_exp_f32 v35, v35
    v_cvt_pk_bf16_f32 v56, v32, v33
    v_cvt_pk_bf16_f32 v57, v34, v35
    ds_write_b128 v225, v[80:83] offset:0
    ds_write_b128 v225, v[84:87] offset:1024
    v_exp_f32 v36, v36
    v_exp_f32 v37, v37
    v_exp_f32 v38, v38
    v_exp_f32 v39, v39
    v_cvt_pk_bf16_f32 v58, v36, v37
    v_cvt_pk_bf16_f32 v59, v38, v39
    v_mfma_f32_32x32x16_bf16 v[96:111], v[168:171], v[48:51], v[96:111]
    ds_write_b128 v225, v[88:91] offset:2048
    v_exp_f32 v40, v40
    v_exp_f32 v41, v41
    v_exp_f32 v42, v42
    v_exp_f32 v43, v43
    v_cvt_pk_bf16_f32 v60, v40, v41
    v_cvt_pk_bf16_f32 v61, v42, v43
    v_mfma_f32_32x32x16_bf16 v[96:111], v[172:175], v[52:55], v[96:111]
    ds_write_b128 v225, v[92:95] offset:3072
    v_exp_f32 v44, v44
    v_exp_f32 v45, v45
    v_exp_f32 v46, v46
    v_exp_f32 v47, v47
    v_cvt_pk_bf16_f32 v62, v44, v45
    v_cvt_pk_bf16_f32 v63, v46, v47
    s_nop 1
    v_mfma_f32_32x32x16_bf16 v[112:127], v[168:171], v[56:59], v[112:127]
    v_mfma_f32_32x32x16_bf16 v[112:127], v[172:175], v[60:63], v[112:127]
    v_mov_b32 v3, 158724
    v_mov_b32 v4, 1
    ds_write_b128 v226, v[96:99] offset:0
    ds_write_b128 v226, v[100:103] offset:1024
    ds_write_b128 v226, v[104:107] offset:2048
    ds_write_b128 v226, v[108:111] offset:3072
    s_mov_b64 exec, 1
    ds_add_u32 v3, v4
    s_mov_b64 exec, -1
    s_mov_b32 s61, 320000
LS_38:
    ds_read_b32 v4, v3
    s_waitcnt lgkmcnt(0)
    v_cmp_gt_u32 vcc, 4, v4
    s_cbranch_vccz LSD_39
    s_sub_u32 s61, s61, 1
    s_cmp_lg_u32 s61, 0
    s_cbranch_scc1 LS_38
LSD_39:
    ds_read_b128 v[64:67], v227 offset:0
    ds_read_b128 v[68:71], v227 offset:1024
    ds_read_b128 v[72:75], v227 offset:2048
    ds_read_b128 v[76:79], v227 offset:3072
    ds_read_b128 v[80:83], v227 offset:4096
    ds_read_b128 v[84:87], v227 offset:5120
    ds_read_b128 v[88:91], v227 offset:6144
    ds_read_b128 v[92:95], v227 offset:7168
    ds_read_b128 v[96:99], v227 offset:8192
    ds_read_b128 v[100:103], v227 offset:9216
    ds_read_b128 v[104:107], v227 offset:10240
    ds_read_b128 v[108:111], v227 offset:11264
    s_mov_b32 s44, 0x07800000
    s_waitcnt lgkmcnt(8)
    v_add_f32 v112, v112, v64
    v_add_f32 v113, v113, v65
    v_add_f32 v114, v114, v66
    v_add_f32 v115, v115, v67
    v_add_f32 v116, v116, v68
    v_add_f32 v117, v117, v69
    v_add_f32 v118, v118, v70
    v_add_f32 v119, v119, v71
    v_add_f32 v120, v120, v72
    v_add_f32 v121, v121, v73
    v_add_f32 v122, v122, v74
    v_add_f32 v123, v123, v75
    v_add_f32 v124, v124, v76
    v_add_f32 v125, v125, v77
    v_add_f32 v126, v126, v78
    v_add_f32 v127, v127, v79
    s_waitcnt lgkmcnt(0)
    v_add_f32 v80, v80, v96
    v_add_f32 v81, v81, v97
    v_add_f32 v82, v82, v98
    v_add_f32 v83, v83, v99
    v_add_f32 v84, v84, v100
    v_add_f32 v85, v85, v101
    v_add_f32 v86, v86, v102
    v_add_f32 v87, v87, v103
    v_add_f32 v88, v88, v104
    v_add_f32 v89, v89, v105
    v_add_f32 v90, v90, v106
    v_add_f32 v91, v91, v107
    v_add_f32 v92, v92, v108
    v_add_f32 v93, v93, v109
    v_add_f32 v94, v94, v110
    v_add_f32 v95, v95, v111
    v_add_f32 v112, v112, v80
    v_add_f32 v113, v113, v81
    v_add_f32 v114, v114, v82
    v_add_f32 v115, v115, v83
    v_add_f32 v116, v116, v84
    v_add_f32 v117, v117, v85
    v_add_f32 v118, v118, v86
    v_add_f32 v119, v119, v87
    v_add_f32 v120, v120, v88
    v_add_f32 v121, v121, v89
    v_add_f32 v122, v122, v90
    v_add_f32 v123, v123, v91
    v_add_f32 v124, v124, v92
    v_add_f32 v125, v125, v93
    v_add_f32 v126, v126, v94
    v_add_f32 v127, v127, v95
    v_add_f32 v5, |v112|, |v113|
    v_add_f32 v5, v5, |v114|
    v_add_f32 v5, v5, |v115|
    v_add_f32 v5, v5, |v116|
    v_add_f32 v5, v5, |v117|
    v_add_f32 v5, v5, |v118|
    v_add_f32 v5, v5, |v119|
    v_add_f32 v5, v5, |v120|
    v_add_f32 v5, v5, |v121|
    v_add_f32 v5, v5, |v122|
    v_add_f32 v5, v5, |v123|
    v_cmp_gt_f32 s[54:55], s44, v5
    v_add_f32 v5, v5, |v124|
    v_add_f32 v5, v5, |v125|
    v_add_f32 v5, v5, |v126|
    v_add_f32 v5, v5, |v127|
    v_mov_b32 v6, 0x7b800000
    v_cmp_nlt_f32 vcc, v5, v6
    s_or_b64 vcc, vcc, s[54:55]
    s_cbranch_vccnz ATT_SLOW
ATT_FIN:
    v_mov_b32 v5, v124
    v_mov_b32 v6, v124
    s_nop 1
    v_permlane32_swap_b32 v5, v6
    s_nop 0
    v_rcp_f32 v6, v6
    v_add_u32 v5, -1, v2
    v_mul_f32 v112, v6, v112
    v_mul_f32 v113, v6, v113
    v_mul_f32 v114, v6, v114
    v_mul_f32 v115, v6, v115
    v_mul_f32 v116, v6, v116
    v_mul_f32 v117, v6, v117
    v_mul_f32 v118, v6, v118
    v_mul_f32 v119, v6, v119
    v_cvt_pk_bf16_f32 v112, v112, v113
    v_cvt_pk_bf16_f32 v113, v114, v115
    v_cvt_pk_bf16_f32 v114, v116, v117
    v_cvt_pk_bf16_f32 v115, v118, v119
    v_min_u32 v112, 0xfffeffff, v112
    buffer_store_dwordx4 v[112:115], v13, s[36:39], 0 offen offset:0 sc1
    v_mul_f32 v120, v6, v120
    v_mul_f32 v121, v6, v121
    v_mul_f32 v122, v6, v122
    v_mul_f32 v123, v6, v123
    v_mul_f32 v124, v6, v124
    v_mul_f32 v125, v6, v125
    v_mul_f32 v126, v6, v126
    v_mul_f32 v127, v6, v127
    v_cvt_pk_bf16_f32 v120, v120, v121
    v_cvt_pk_bf16_f32 v121, v122, v123
    v_cvt_pk_bf16_f32 v122, v124, v125
    v_cvt_pk_bf16_f32 v123, v126, v127
    v_min_u32 v120, 0xfffeffff, v120
    v_and_b32 v122, v5, v122
    v_and_b32 v123, v5, v123
    buffer_store_dwordx4 v[120:123], v13, s[36:39], 0 offen offset:1024 sc1
    s_cmp_ge_u32 s2, 224
    s_cbranch_scc1 A_DONE
    v_mov_b32 v10, v247
    v_mov_b32 v11, v248
    v_xor_b32 v12, 64, v248
    v_mov_b32 v14, v227
    v_mov_b32 v15, v246
    v_mov_b32 v3, 158880
    s_mov_b32 s61, 320000
LS_40:
    ds_read_b128 v[16:19], v3
    s_waitcnt lgkmcnt(0)
    v_cmp_eq_u32 vcc, -1, v16
    v_cmp_eq_u32 s[54:55], -1, v17
    s_or_b64 vcc, vcc, s[54:55]
    v_cmp_eq_u32 s[54:55], -1, v18
    s_or_b64 vcc, vcc, s[54:55]
    v_cmp_eq_u32 s[54:55], -1, v19
    s_or_b64 vcc, vcc, s[54:55]
    s_cbranch_vccz LSD_41
    s_sleep 1
    s_sub_u32 s61, s61, 1
    s_cmp_lg_u32 s61, 0
    s_cbranch_scc1 LS_40
LSD_41:
    s_mov_b32 s56, 0
    ds_read_b64_tr_b16 v[128:129], v11 offset:0
    ds_read_b64_tr_b16 v[130:131], v11 offset:1024
    ds_read_b64_tr_b16 v[132:133], v12 offset:0
    ds_read_b64_tr_b16 v[134:135], v12 offset:1024
    buffer_load_dwordx4 v[48:51], v10, s[36:39], s56 offen offset:0 sc1
    ds_read_b64_tr_b16 v[136:137], v11 offset:2048
    ds_read_b64_tr_b16 v[138:139], v11 offset:3072
    ds_read_b64_tr_b16 v[140:141], v12 offset:2048
    buffer_load_dwordx4 v[52:55], v10, s[36:39], s56 offen offset:1024 sc1
    ds_read_b64_tr_b16 v[142:143], v12 offset:3072
    ds_read_b64_tr_b16 v[144:145], v11 offset:3584
    ds_read_b64_tr_b16 v[146:147], v11 offset:4608
    buffer_load_dwordx4 v[56:59], v10, s[36:39], s56 offen offset:2048 sc1
    ds_read_b64_tr_b16 v[148:149], v12 offset:3584
    ds_read_b64_tr_b16 v[150:151], v12 offset:4608
    ds_read_b64_tr_b16 v[152:153], v11 offset:5632
    buffer_load_dwordx4 v[60:63], v10, s[36:39], s56 offen offset:3072 sc1
    ds_read_b64_tr_b16 v[154:155], v11 offset:6656
    ds_read_b64_tr_b16 v[156:157], v12 offset:5632
    ds_read_b64_tr_b16 v[158:159], v12 offset:6656
    s_mov_b32 s56, 4096
    ds_read_b64_tr_b16 v[160:161], v11 offset:7168
    ds_read_b64_tr_b16 v[162:163], v11 offset:8192
    ds_read_b64_tr_b16 v[164:165], v12 offset:7168
    ds_read_b64_tr_b16 v[166:167], v12 offset:8192
    buffer_load_dwordx4 v[64:67], v10, s[36:39], s56 offen offset:0 sc1
    ds_read_b64_tr_b16 v[168:169], v11 offset:9216
    ds_read_b64_tr_b16 v[170:171], v11 offset:10240
    ds_read_b64_tr_b16 v[172:173], v12 offset:9216
    buffer_load_dwordx4 v[68:71], v10, s[36:39], s56 offen offset:1024 sc1
    ds_read_b64_tr_b16 v[174:175], v12 offset:10240
    ds_read_b64_tr_b16 v[176:177], v11 offset:10752
    ds_read_b64_tr_b16 v[178:179], v11 offset:11776
    buffer_load_dwordx4 v[72:75], v10, s[36:39], s56 offen offset:2048 sc1
    ds_read_b64_tr_b16 v[180:181], v12 offset:10752
    ds_read_b64_tr_b16 v[182:183], v12 offset:11776
    ds_read_b64_tr_b16 v[184:185], v11 offset:12800
    buffer_load_dwordx4 v[76:79], v10, s[36:39], s56 offen offset:3072 sc1
    ds_read_b64_tr_b16 v[186:187], v11 offset:13824
    ds_read_b64_tr_b16 v[188:189], v12 offset:12800
    ds_read_b64_tr_b16 v[190:191], v12 offset:13824
    s_mov_b32 s56, 8192
    v_mov_b32 v16, 0
    v_mov_b32 v17, 0
    v_mov_b32 v18, 0
    v_mov_b32 v19, 0
    buffer_load_dwordx4 v[80:83], v10, s[36:39], s56 offen offset:0 sc1
    v_mov_b32 v20, 0
    v_mov_b32 v21, 0
    v_mov_b32 v22, 0
    buffer_load_dwordx4 v[84:87], v10, s[36:39], s56 offen offset:1024 sc1
    v_mov_b32 v23, 0
    v_mov_b32 v24, 0
    v_mov_b32 v25, 0
    buffer_load_dwordx4 v[88:91], v10, s[36:39], s56 offen offset:2048 sc1
    v_mov_b32 v26, 0
    v_mov_b32 v27, 0
    v_mov_b32 v28, 0
    buffer_load_dwordx4 v[92:95], v10, s[36:39], s56 offen offset:3072 sc1
    v_mov_b32 v29, 0
    v_mov_b32 v30, 0
    v_mov_b32 v31, 0
    s_mov_b32 s56, 12288
    v_mov_b32 v32, 0
    v_mov_b32 v33, 0
    v_mov_b32 v34, 0
    v_mov_b32 v35, 0
    buffer_load_dwordx4 v[96:99], v10, s[36:39], s56 offen offset:0 sc1
    v_mov_b32 v36, 0
    v_mov_b32 v37, 0
    v_mov_b32 v38, 0
    buffer_load_dwordx4 v[100:103], v10, s[36:39], s56 offen offset:1024 sc1
    v_mov_b32 v39, 0
    v_mov_b32 v40, 0
    v_mov_b32 v41, 0
    buffer_load_dwordx4 v[104:107], v10, s[36:39], s56 offen offset:2048 sc1
    v_mov_b32 v42, 0
    v_mov_b32 v43, 0
    v_mov_b32 v44, 0
    buffer_load_dwordx4 v[108:111], v10, s[36:39], s56 offen offset:3072 sc1
    v_mov_b32 v45, 0
    v_mov_b32 v46, 0
    v_mov_b32 v47, 0
    s_mov_b32 s61, 40000
    s_mov_b32 s44, 0
    v_mov_b32 v4, 0
    s_waitcnt vmcnt(12) lgkmcnt(0)
    v_max3_u32 v3, v48, v52, v56
    v_max_u32 v3, v3, v60
    v_cmp_eq_u32 vcc, -1, v3
    s_cbranch_vccnz O_F0
    v_mfma_f32_32x32x16_bf16 v[16:31], v[128:131], v[48:51], v[16:31]
    ds_read_b64_tr_b16 v[192:193], v11 offset:14336
    ds_read_b64_tr_b16 v[194:195], v11 offset:15360
    v_mfma_f32_32x32x16_bf16 v[16:31], v[136:139], v[52:55], v[16:31]
    ds_read_b64_tr_b16 v[196:197], v12 offset:14336
    ds_read_b64_tr_b16 v[198:199], v12 offset:15360
    v_mfma_f32_32x32x16_bf16 v[16:31], v[144:147], v[56:59], v[16:31]
    ds_read_b64_tr_b16 v[200:201], v11 offset:16384
    ds_read_b64_tr_b16 v[202:203], v11 offset:17408
    v_mfma_f32_32x32x16_bf16 v[16:31], v[152:155], v[60:63], v[16:31]
    ds_read_b64_tr_b16 v[204:205], v12 offset:16384
    ds_read_b64_tr_b16 v[206:207], v12 offset:17408
    v_mfma_f32_32x32x16_bf16 v[32:47], v[132:135], v[48:51], v[32:47]
    ds_read_b64_tr_b16 v[208:209], v11 offset:17920
    ds_read_b64_tr_b16 v[210:211], v11 offset:18944
    v_mfma_f32_32x32x16_bf16 v[32:47], v[140:143], v[52:55], v[32:47]
    ds_read_b64_tr_b16 v[212:213], v12 offset:17920
    ds_read_b64_tr_b16 v[214:215], v12 offset:18944
    v_mfma_f32_32x32x16_bf16 v[32:47], v[148:151], v[56:59], v[32:47]
    ds_read_b64_tr_b16 v[216:217], v11 offset:19968
    ds_read_b64_tr_b16 v[218:219], v11 offset:20992
    v_mfma_f32_32x32x16_bf16 v[32:47], v[156:159], v[60:63], v[32:47]
    ds_read_b64_tr_b16 v[220:221], v12 offset:19968
    ds_read_b64_tr_b16 v[222:223], v12 offset:20992
O_FR0:
    s_waitcnt vmcnt(8) lgkmcnt(0)
    v_max3_u32 v3, v64, v68, v72
    v_max_u32 v3, v3, v76
    v_cmp_eq_u32 vcc, -1, v3
    s_cbranch_vccnz O_F1
    v_mfma_f32_32x32x16_bf16 v[16:31], v[160:163], v[64:67], v[16:31]
    ds_read_b64_tr_b16 v[224:225], v11 offset:21504
    ds_read_b64_tr_b16 v[226:227], v11 offset:22528
    v_mfma_f32_32x32x16_bf16 v[16:31], v[168:171], v[68:71], v[16:31]
    ds_read_b64_tr_b16 v[228:229], v12 offset:21504
    ds_read_b64_tr_b16 v[230:231], v12 offset:22528
    v_mfma_f32_32x32x16_bf16 v[16:31], v[176:179], v[72:75], v[16:31]
    ds_read_b64_tr_b16 v[232:233], v11 offset:23552
    ds_read_b64_tr_b16 v[234:235], v11 offset:24576
    v_mfma_f32_32x32x16_bf16 v[16:31], v[184:187], v[76:79], v[16:31]
    ds_read_b64_tr_b16 v[236:237], v12 offset:23552
    ds_read_b64_tr_b16 v[238:239], v12 offset:24576
    v_mfma_f32_32x32x16_bf16 v[32:47], v[164:167], v[64:67], v[32:47]
    ds_read_b64_tr_b16 v[240:241], v11 offset:25088
    ds_read_b64_tr_b16 v[242:243], v11 offset:26112
    v_mfma_f32_32x32x16_bf16 v[32:47], v[172:175], v[68:71], v[32:47]
    ds_read_b64_tr_b16 v[244:245], v12 offset:25088
    ds_read_b64_tr_b16 v[246:247], v12 offset:26112
    v_mfma_f32_32x32x16_bf16 v[32:47], v[180:183], v[72:75], v[32:47]
    ds_read_b64_tr_b16 v[248:249], v11 offset:27136
    ds_read_b64_tr_b16 v[250:251], v11 offset:28160
    v_mfma_f32_32x32x16_bf16 v[32:47], v[188:191], v[76:79], v[32:47]
    ds_read_b64_tr_b16 v[252:253], v12 offset:27136
    ds_read_b64_tr_b16 v[254:255], v12 offset:28160
O_FR1:
    s_waitcnt vmcnt(4) lgkmcnt(0)
    v_max3_u32 v3, v80, v84, v88
    v_max_u32 v3, v3, v92
    v_cmp_eq_u32 vcc, -1, v3
    s_cbranch_vccnz O_F2
    v_mfma_f32_32x32x16_bf16 v[16:31], v[192:195], v[80:83], v[16:31]
    v_mfma_f32_32x32x16_bf16 v[16:31], v[200:203], v[84:87], v[16:31]
    v_mfma_f32_32x32x16_bf16 v[16:31], v[208:211], v[88:91], v[16:31]
    v_mfma_f32_32x32x16_bf16 v[16:31], v[216:219], v[92:95], v[16:31]
    v_mfma_f32_32x32x16_bf16 v[32:47], v[196:199], v[80:83], v[32:47]
    v_mfma_f32_32x32x16_bf16 v[32:47], v[204:207], v[84:87], v[32:47]
    v_mfma_f32_32x32x16_bf16 v[32:47], v[212:215], v[88:91], v[32:47]
    v_mfma_f32_32x32x16_bf16 v[32:47], v[220:223], v[92:95], v[32:47]
O_FR2:
    s_waitcnt vmcnt(0) lgkmcnt(0)
    v_max3_u32 v3, v96, v100, v104
    v_max_u32 v3, v3, v108
    v_cmp_eq_u32 vcc, -1, v3
    s_cbranch_vccnz O_F3
    v_mfma_f32_32x32x16_bf16 v[16:31], v[224:227], v[96:99], v[16:31]
    v_mfma_f32_32x32x16_bf16 v[16:31], v[232:235], v[100:103], v[16:31]
    v_mfma_f32_32x32x16_bf16 v[16:31], v[240:243], v[104:107], v[16:31]
    v_mfma_f32_32x32x16_bf16 v[16:31], v[248:251], v[108:111], v[16:31]
    v_mfma_f32_32x32x16_bf16 v[32:47], v[228:231], v[96:99], v[32:47]
    v_mfma_f32_32x32x16_bf16 v[32:47], v[236:239], v[100:103], v[32:47]
    v_mfma_f32_32x32x16_bf16 v[32:47], v[244:247], v[104:107], v[32:47]
    v_mfma_f32_32x32x16_bf16 v[32:47], v[252:255], v[108:111], v[32:47]
O_FR3:
    s_cmp_eq_u32 s44, 0
    s_cbranch_scc1 O_FIN
    s_bitcmp0_b32 s44, 0
    s_cbranch_scc1 O_NR0
    s_mov_b32 s56, 0
    buffer_load_dwordx4 v[48:51], v10, s[36:39], s56 offen offset:0 sc1
    buffer_load_dwordx4 v[52:55], v10, s[36:39], s56 offen offset:1024 sc1
    buffer_load_dwordx4 v[56:59], v10, s[36:39], s56 offen offset:2048 sc1
    buffer_load_dwordx4 v[60:63], v10, s[36:39], s56 offen offset:3072 sc1
O_NR0:
    s_bitcmp0_b32 s44, 1
    s_cbranch_scc1 O_NR1
    s_mov_b32 s56, 4096
    buffer_load_dwordx4 v[64:67], v10, s[36:39], s56 offen offset:0 sc1
    buffer_load_dwordx4 v[68:71], v10, s[36:39], s56 offen offset:1024 sc1
    buffer_load_dwordx4 v[72:75], v10, s[36:39], s56 offen offset:2048 sc1
    buffer_load_dwordx4 v[76:79], v10, s[36:39], s56 offen offset:3072 sc1
O_NR1:
    s_bitcmp0_b32 s44, 2
    s_cbranch_scc1 O_NR2
    s_mov_b32 s56, 8192
    buffer_load_dwordx4 v[80:83], v10, s[36:39], s56 offen offset:0 sc1
    buffer_load_dwordx4 v[84:87], v10, s[36:39], s56 offen offset:1024 sc1
    buffer_load_dwordx4 v[88:91], v10, s[36:39], s56 offen offset:2048 sc1
    buffer_load_dwordx4 v[92:95], v10, s[36:39], s56 offen offset:3072 sc1
O_NR2:
    s_bitcmp0_b32 s44, 3
    s_cbranch_scc1 O_NR3
    s_mov_b32 s56, 12288
    buffer_load_dwordx4 v[96:99], v10, s[36:39], s56 offen offset:0 sc1
    buffer_load_dwordx4 v[100:103], v10, s[36:39], s56 offen offset:1024 sc1
    buffer_load_dwordx4 v[104:107], v10, s[36:39], s56 offen offset:2048 sc1
    buffer_load_dwordx4 v[108:111], v10, s[36:39], s56 offen offset:3072 sc1
O_NR3:
O_TOP:
    s_waitcnt vmcnt(0)
    s_mov_b32 s46, 0
    s_bitcmp0_b32 s44, 0
    s_cbranch_scc1 O_NC0
    v_max3_u32 v3, v48, v52, v56
    v_max_u32 v3, v3, v60
    v_cmp_eq_u32 vcc, -1, v3
    s_cbranch_vccz O_OK0
    s_mov_b32 s56, 0
    buffer_load_dwordx4 v[48:51], v10, s[36:39], s56 offen offset:0 sc1
    buffer_load_dwordx4 v[52:55], v10, s[36:39], s56 offen offset:1024 sc1
    buffer_load_dwordx4 v[56:59], v10, s[36:39], s56 offen offset:2048 sc1
    buffer_load_dwordx4 v[60:63], v10, s[36:39], s56 offen offset:3072 sc1
    s_branch O_NC0
O_OK0:
    s_bitset1_b32 s46, 0
O_NC0:
    s_bitcmp0_b32 s44, 1
    s_cbranch_scc1 O_NC1
    v_max3_u32 v3, v64, v68, v72
    v_max_u32 v3, v3, v76
    v_cmp_eq_u32 vcc, -1, v3
    s_cbranch_vccz O_OK1
    s_mov_b32 s56, 4096
    buffer_load_dwordx4 v[64:67], v10, s[36:39], s56 offen offset:0 sc1
    buffer_load_dwordx4 v[68:71], v10, s[36:39], s56 offen offset:1024 sc1
    buffer_load_dwordx4 v[72:75], v10, s[36:39], s56 offen offset:2048 sc1
    buffer_load_dwordx4 v[76:79], v10, s[36:39], s56 offen offset:3072 sc1
    s_branch O_NC1
O_OK1:
    s_bitset1_b32 s46, 1
O_NC1:
    s_bitcmp0_b32 s44, 2
    s_cbranch_scc1 O_NC2
    v_max3_u32 v3, v80, v84, v88
    v_max_u32 v3, v3, v92
    v_cmp_eq_u32 vcc, -1, v3
    s_cbranch_vccz O_OK2
    s_mov_b32 s56, 8192
    buffer_load_dwordx4 v[80:83], v10, s[36:39], s56 offen offset:0 sc1
    buffer_load_dwordx4 v[84:87], v10, s[36:39], s56 offen offset:1024 sc1
    buffer_load_dwordx4 v[88:91], v10, s[36:39], s56 offen offset:2048 sc1
    buffer_load_dwordx4 v[92:95], v10, s[36:39], s56 offen offset:3072 sc1
    s_branch O_NC2
O_OK2:
    s_bitset1_b32 s46, 2
O_NC2:
    s_bitcmp0_b32 s44, 3
    s_cbranch_scc1 O_NC3
    v_max3_u32 v3, v96, v100, v104
    v_max_u32 v3, v3, v108
    v_cmp_eq_u32 vcc, -1, v3
    s_cbranch_vccz O_OK3
    s_mov_b32 s56, 12288
    buffer_load_dwordx4 v[96:99], v10, s[36:39], s56 offen offset:0 sc1
    buffer_load_dwordx4 v[100:103], v10, s[36:39], s56 offen offset:1024 sc1
    buffer_load_dwordx4 v[104:107], v10, s[36:39], s56 offen offset:2048 sc1
    buffer_load_dwordx4 v[108:111], v10, s[36:39], s56 offen offset:3072 sc1
    s_branch O_NC3
O_OK3:
    s_bitset1_b32 s46, 3
O_NC3:
    s_andn2_b32 s44, s44, s46
    s_bitcmp0_b32 s46, 0
    s_cbranch_scc1 O_NW0
    v_mfma_f32_32x32x16_bf16 v[16:31], v[128:131], v[48:51], v[16:31]
    v_mfma_f32_32x32x16_bf16 v[16:31], v[136:139], v[52:55], v[16:31]
    v_mfma_f32_32x32x16_bf16 v[16:31], v[144:147], v[56:59], v[16:31]
    v_mfma_f32_32x32x16_bf16 v[16:31], v[152:155], v[60:63], v[16:31]
    v_mfma_f32_32x32x16_bf16 v[32:47], v[132:135], v[48:51], v[32:47]
    v_mfma_f32_32x32x16_bf16 v[32:47], v[140:143], v[52:55], v[32:47]
    v_mfma_f32_32x32x16_bf16 v[32:47], v[148:151], v[56:59], v[32:47]
    v_mfma_f32_32x32x16_bf16 v[32:47], v[156:159], v[60:63], v[32:47]
O_NW0:
    s_bitcmp0_b32 s46, 1
    s_cbranch_scc1 O_NW1
    v_mfma_f32_32x32x16_bf16 v[16:31], v[160:163], v[64:67], v[16:31]
    v_mfma_f32_32x32x16_bf16 v[16:31], v[168:171], v[68:71], v[16:31]
    v_mfma_f32_32x32x16_bf16 v[16:31], v[176:179], v[72:75], v[16:31]
    v_mfma_f32_32x32x16_bf16 v[16:31], v[184:187], v[76:79], v[16:31]
    v_mfma_f32_32x32x16_bf16 v[32:47], v[164:167], v[64:67], v[32:47]
    v_mfma_f32_32x32x16_bf16 v[32:47], v[172:175], v[68:71], v[32:47]
    v_mfma_f32_32x32x16_bf16 v[32:47], v[180:183], v[72:75], v[32:47]
    v_mfma_f32_32x32x16_bf16 v[32:47], v[188:191], v[76:79], v[32:47]
O_NW1:
    s_bitcmp0_b32 s46, 2
    s_cbranch_scc1 O_NW2
    v_mfma_f32_32x32x16_bf16 v[16:31], v[192:195], v[80:83], v[16:31]
    v_mfma_f32_32x32x16_bf16 v[16:31], v[200:203], v[84:87], v[16:31]
    v_mfma_f32_32x32x16_bf16 v[16:31], v[208:211], v[88:91], v[16:31]
    v_mfma_f32_32x32x16_bf16 v[16:31], v[216:219], v[92:95], v[16:31]
    v_mfma_f32_32x32x16_bf16 v[32:47], v[196:199], v[80:83], v[32:47]
    v_mfma_f32_32x32x16_bf16 v[32:47], v[204:207], v[84:87], v[32:47]
    v_mfma_f32_32x32x16_bf16 v[32:47], v[212:215], v[88:91], v[32:47]
    v_mfma_f32_32x32x16_bf16 v[32:47], v[220:223], v[92:95], v[32:47]
O_NW2:
    s_bitcmp0_b32 s46, 3
    s_cbranch_scc1 O_NW3
    v_mfma_f32_32x32x16_bf16 v[16:31], v[224:227], v[96:99], v[16:31]
    v_mfma_f32_32x32x16_bf16 v[16:31], v[232:235], v[100:103], v[16:31]
    v_mfma_f32_32x32x16_bf16 v[16:31], v[240:243], v[104:107], v[16:31]
    v_mfma_f32_32x32x16_bf16 v[16:31], v[248:251], v[108:111], v[16:31]
    v_mfma_f32_32x32x16_bf16 v[32:47], v[228:231], v[96:99], v[32:47]
    v_mfma_f32_32x32x16_bf16 v[32:47], v[236:239], v[100:103], v[32:47]
    v_mfma_f32_32x32x16_bf16 v[32:47], v[244:247], v[104:107], v[32:47]
    v_mfma_f32_32x32x16_bf16 v[32:47], v[252:255], v[108:111], v[32:47]
O_NW3:
    s_cmp_eq_u32 s44, 0
    s_cbranch_scc1 O_FIN
    s_sub_u32 s61, s61, 1
    s_cmp_lg_u32 s61, 0
    s_cbranch_scc1 O_TOP
O_FIN:
    s_nop 3
    s_nop 7
    ds_write_b128 v14, v[16:19] offset:0
    ds_write_b128 v14, v[20:23] offset:1024
    ds_write_b128 v14, v[24:27] offset:2048
    ds_write_b128 v14, v[28:31] offset:3072
    ds_write_b128 v14, v[32:35] offset:4096
    ds_write_b128 v14, v[36:39] offset:5120
    ds_write_b128 v14, v[40:43] offset:6144
    ds_write_b128 v14, v[44:47] offset:7168
    ds_write_b32 v15, v4 offset:32
A_DONE:
    s_endpgm
O_F0:
    s_bitset1_b32 s44, 0
    ds_read_b64_tr_b16 v[192:193], v11 offset:14336
    ds_read_b64_tr_b16 v[194:195], v11 offset:15360
    ds_read_b64_tr_b16 v[196:197], v12 offset:14336
    ds_read_b64_tr_b16 v[198:199], v12 offset:15360
    ds_read_b64_tr_b16 v[200:201], v11 offset:16384
    ds_read_b64_tr_b16 v[202:203], v11 offset:17408
    ds_read_b64_tr_b16 v[204:205], v12 offset:16384
    ds_read_b64_tr_b16 v[206:207], v12 offset:17408
    ds_read_b64_tr_b16 v[208:209], v11 offset:17920
    ds_read_b64_tr_b16 v[210:211], v11 offset:18944
    ds_read_b64_tr_b16 v[212:213], v12 offset:17920
    ds_read_b64_tr_b16 v[214:215], v12 offset:18944
    ds_read_b64_tr_b16 v[216:217], v11 offset:19968
    ds_read_b64_tr_b16 v[218:219], v11 offset:20992
    ds_read_b64_tr_b16 v[220:221], v12 offset:19968
    ds_read_b64_tr_b16 v[222:223], v12 offset:20992
    s_branch O_FR0
O_F1:
    s_bitset1_b32 s44, 1
    ds_read_b64_tr_b16 v[224:225], v11 offset:21504
    ds_read_b64_tr_b16 v[226:227], v11 offset:22528
    ds_read_b64_tr_b16 v[228:229], v12 offset:21504
    ds_read_b64_tr_b16 v[230:231], v12 offset:22528
    ds_read_b64_tr_b16 v[232:233], v11 offset:23552
    ds_read_b64_tr_b16 v[234:235], v11 offset:24576
    ds_read_b64_tr_b16 v[236:237], v12 offset:23552
    ds_read_b64_tr_b16 v[238:239], v12 offset:24576
    ds_read_b64_tr_b16 v[240:241], v11 offset:25088
    ds_read_b64_tr_b16 v[242:243], v11 offset:26112
    ds_read_b64_tr_b16 v[244:245], v12 offset:25088
    ds_read_b64_tr_b16 v[246:247], v12 offset:26112
    ds_read_b64_tr_b16 v[248:249], v11 offset:27136
    ds_read_b64_tr_b16 v[250:251], v11 offset:28160
    ds_read_b64_tr_b16 v[252:253], v12 offset:27136
    ds_read_b64_tr_b16 v[254:255], v12 offset:28160
    s_branch O_FR1
O_F2:
    s_bitset1_b32 s44, 2
    s_branch O_FR2
O_F3:
    s_bitset1_b32 s44, 3
    s_branch O_FR3
ATT_FWAIT:
    s_mov_b32 s61, 320000
LS_42:
    ds_read_b128 v[236:239], v5
    s_waitcnt lgkmcnt(0)
    v_cmp_eq_u32 vcc, -1, v236
    v_cmp_eq_u32 s[54:55], -1, v237
    s_or_b64 vcc, vcc, s[54:55]
    v_cmp_eq_u32 s[54:55], -1, v238
    s_or_b64 vcc, vcc, s[54:55]
    v_cmp_eq_u32 s[54:55], -1, v239
    s_or_b64 vcc, vcc, s[54:55]
    s_cbranch_vccz LSD_43
    s_sub_u32 s61, s61, 1
    s_cmp_lg_u32 s61, 0
    s_cbranch_scc1 LS_42
LSD_43:
    s_branch ATT_FOK
A_SPC0:
    v_mov_b32 v130, 0x3f803f80
    v_mov_b32 v131, 0x00003f80
    buffer_store_dwordx4 v[128:131], v29, s[36:39], s4 offen sc1
    s_branch A_SPR0
A_SPC1:
    v_mov_b32 v134, 0x3f803f80
    v_mov_b32 v135, 0x00003f80
    buffer_store_dwordx4 v[132:135], v29, s[36:39], s5 offen sc1
    s_branch A_SPR1
A_SPC2:
    v_mov_b32 v138, 0x3f803f80
    v_mov_b32 v139, 0x00003f80
    buffer_store_dwordx4 v[136:139], v29, s[36:39], s6 offen sc1
    s_branch A_SPR2
A_SPC3:
    v_mov_b32 v142, 0x3f803f80
    v_mov_b32 v143, 0x00003f80
    buffer_store_dwordx4 v[140:143], v29, s[36:39], s7 offen sc1
    s_branch A_SPR3
A_SPC4:
    v_mov_b32 v146, 0x3f803f80
    v_mov_b32 v147, 0x00003f80
    buffer_store_dwordx4 v[144:147], v29, s[36:39], s8 offen sc1
    s_branch A_SPR4
A_SPC5:
    v_mov_b32 v150, 0x3f803f80
    v_mov_b32 v151, 0x00003f80
    buffer_store_dwordx4 v[148:151], v29, s[36:39], s9 offen sc1
    s_branch A_SPR5
A_SPC6:
    v_mov_b32 v154, 0x3f803f80
    v_mov_b32 v155, 0x00003f80
    buffer_store_dwordx4 v[152:155], v29, s[36:39], s10 offen sc1
    s_branch A_SPR6
A_SPC7:
    v_mov_b32 v158, 0x3f803f80
    v_mov_b32 v159, 0x00003f80
    buffer_store_dwordx4 v[156:159], v29, s[36:39], s11 offen sc1
    s_branch A_SPR7
ATT_SLOW:
    s_lshl_b32 s53, s50, 17
    s_add_u32 s53, s53, 2097152
    v_lshl_add_u32 v12, v0, 4, s53
    s_lshl_b32 s53, s49, 4
    s_add_u32 s53, s53, 18
    v_mul_lo_u32 v3, v15, s53
    v_sub_u32 v14, v14, v3
    s_mov_b64 exec, s[22:23]
    v_mov_b32 v158, 0
    v_mov_b32 v159, 0
    s_mov_b64 exec, -1
    v_mov_b32 v3, 0xff800000
    s_mov_b32 s56, 0
SLOW_MAX:
    buffer_load_dwordx4 v[160:163], v12, s[36:39], s56 offen offset:0 sc1
    buffer_load_dwordx4 v[164:167], v12, s[36:39], s56 offen offset:1024 sc1
    s_waitcnt vmcnt(0)
    v_mfma_f32_32x32x16_bf16 v[16:31], v[160:163], v[152:155], 0
    v_mfma_f32_32x32x16_bf16 v[16:31], v[164:167], v[156:159], v[16:31]
    s_add_u32 s56, s56, 2048
    s_nop 11
    v_max3_f32 v3, v3, v16, v17
    v_max3_f32 v3, v3, v18, v19
    v_max3_f32 v3, v3, v20, v21
    v_max3_f32 v3, v3, v22, v23
    v_max3_f32 v3, v3, v24, v25
    v_max3_f32 v3, v3, v26, v27
    v_max3_f32 v3, v3, v28, v29
    v_max3_f32 v3, v3, v30, v31
    s_cmp_lt_u32 s56, 131072
    s_cbranch_scc1 SLOW_MAX
    v_mov_b32 v4, v3
    s_nop 1
    v_permlane32_swap_b32 v3, v4
    s_nop 0
    v_max_f32 v3, v3, v4
    v_sub_f32 v3, 0x80000000, v3
    v_and_b32 v4, 0xffff0000, v3
    v_sub_f32 v3, v3, v4
    v_and_b32 v5, 0xffff0000, v3
    v_sub_f32 v3, v3, v5
    v_lshrrev_b32 v4, 16, v4
    v_or_b32 v10, v4, v5
    v_lshrrev_b32 v11, 16, v3
    s_mov_b64 exec, s[22:23]
    v_mov_b32 v158, v10
    v_mov_b32 v159, v11
    s_mov_b64 exec, -1
    v_mov_b32 v112, 0
    v_mov_b32 v113, 0
    v_mov_b32 v114, 0
    v_mov_b32 v115, 0
    v_mov_b32 v116, 0
    v_mov_b32 v117, 0
    v_mov_b32 v118, 0
    v_mov_b32 v119, 0
    v_mov_b32 v120, 0
    v_mov_b32 v121, 0
    v_mov_b32 v122, 0
    v_mov_b32 v123, 0
    v_mov_b32 v124, 0
    v_mov_b32 v125, 0
    v_mov_b32 v126, 0
    v_mov_b32 v127, 0
    s_mov_b32 s56, 0
SLOW_PV:
    buffer_load_dwordx4 v[160:163], v12, s[36:39], s56 offen offset:0 sc1
    buffer_load_dwordx4 v[168:171], v14, s[36:39], 0 offen offset:0 sc1
    buffer_load_dwordx4 v[164:167], v12, s[36:39], s56 offen offset:1024 sc1
    buffer_load_dwordx4 v[172:175], v14, s[36:39], 0 offen offset:1024 sc1
    v_add_u32 v14, v15, v14
    s_waitcnt vmcnt(0)
    v_mfma_f32_32x32x16_bf16 v[16:31], v[160:163], v[152:155], 0
    v_mfma_f32_32x32x16_bf16 v[16:31], v[164:167], v[156:159], v[16:31]
    s_add_u32 s56, s56, 2048
    s_nop 11
    v_exp_f32 v16, v16
    v_exp_f32 v17, v17
    v_exp_f32 v18, v18
    v_exp_f32 v19, v19
    v_exp_f32 v20, v20
    v_exp_f32 v21, v21
    v_exp_f32 v22, v22
    v_exp_f32 v23, v23
    v_exp_f32 v24, v24
    v_exp_f32 v25, v25
    v_exp_f32 v26, v26
    v_exp_f32 v27, v27
    v_exp_f32 v28, v28
    v_exp_f32 v29, v29
    v_exp_f32 v30, v30
    v_exp_f32 v31, v31
    s_nop 0
    v_cvt_pk_bf16_f32 v48, v16, v17
    v_cvt_pk_bf16_f32 v49, v18, v19
    v_cvt_pk_bf16_f32 v50, v20, v21
    v_cvt_pk_bf16_f32 v51, v22, v23
    v_cvt_pk_bf16_f32 v52, v24, v25
    v_cvt_pk_bf16_f32 v53, v26, v27
    v_cvt_pk_bf16_f32 v54, v28, v29
    v_cvt_pk_bf16_f32 v55, v30, v31
    s_nop 1
    v_mfma_f32_32x32x16_bf16 v[112:127], v[168:171], v[48:51], v[112:127]
    v_mfma_f32_32x32x16_bf16 v[112:127], v[172:175], v[52:55], v[112:127]
    s_cmp_lt_u32 s56, 131072
    s_cbranch_scc1 SLOW_PV
    s_nop 11
    s_branch ATT_FIN
SPARE:
    s_and_b32 s49, s48, 3
    s_bfe_u32 s55, s2, 0x20003
    s_lshl_b32 s54, s49, 2
    s_add_u32 s60, s55, s54
    s_lshl_b32 s54, s48, 2
    s_add_u32 s53, s55, s54
    s_cmp_ge_u32 s53, (CODE_END-ENTRY+1023)/1024
    s_cbranch_scc1 R_NOCPF
    s_getpc_b64 s[44:45]
R_PC:
    s_sub_u32 s44, s44, R_PC-ENTRY
    s_subb_u32 s45, s45, 0
    s_lshl_b32 s53, s53, 10
    v_lshl_add_u32 v3, v0, 4, s53
    v_min_u32 v3, CODE_END-ENTRY-16, v3
    global_load_dwordx4 v[248:251], v3, s[44:45]
R_NOCPF:
    s_and_b32 s53, s2, 3
    s_lshl_b32 s53, s53, 9
    s_bfe_u32 s54, s2, 0x10002
    s_lshl_b32 s54, s54, 8
    s_add_u32 s53, s53, s54
    s_lshl_b32 s54, s55, 3
    s_add_u32 s54, s54, s48
    s_lshl_b32 s54, s54, 3
    s_add_u32 s53, s53, s54
    v_lshrrev_b32 v244, 3, v0
    v_add_u32 v244, s53, v244
    v_mul_u32_u24 v3, 896, v244
    v_and_b32 v4, 7, v0
    v_lshl_add_u32 v3, v4, 4, v3
    s_waitcnt lgkmcnt(0)
    s_mov_b32 s24, s4
    s_mov_b32 s25, s5
    s_mov_b32 s26, 1835008
    s_mov_b32 s27, 0x00020000
    s_mov_b32 s36, s20
    s_mov_b32 s37, s21
    s_mov_b32 s38, 268435456
    s_mov_b32 s39, 0x00020000
    v_mov_b32 v243, 19136512
    buffer_load_dword v243, v243, s[36:39], 0 offen sc1
    buffer_load_dwordx4 v[204:207], v3, s[24:27], 0 offen offset:0
    buffer_load_dwordx4 v[208:211], v3, s[24:27], 0 offen offset:128
    buffer_load_dwordx4 v[212:215], v3, s[24:27], 0 offen offset:256
    buffer_load_dwordx4 v[216:219], v3, s[24:27], 0 offen offset:384
    buffer_load_dwordx4 v[220:223], v3, s[24:27], 0 offen offset:512
    buffer_load_dwordx4 v[224:227], v3, s[24:27], 0 offen offset:640
    buffer_load_dwordx4 v[228:231], v3, s[24:27], 0 offen offset:768
    v_and_b32 v1, 31, v0
    v_lshrrev_b32 v2, 5, v0
    s_mov_b32 s3, 0x3f803f80
    s_mov_b32 s22, 0
    s_mov_b32 s23, -1
    s_lshr_b32 s53, s2, 4
    s_lshl_b32 s53, s53, 2
    s_add_u32 s53, s53, s49
    s_mul_i32 s53, s53, 147456
    s_and_b32 s54, s2, 15
    s_lshl_b32 s54, s54, 11
    s_add_u32 s53, s53, s54
    s_add_u32 s53, s53, 6406144
    v_lshl_add_u32 v13, v0, 4, s53
    s_and_b32 s47, s2, 31
    s_lshl_b32 s47, s47, 11
    s_add_u32 s47, s47, 4194304
    v_lshlrev_b32 v3, 2, v0
    s_lshl_b32 s53, s49, 8
    s_add_u32 s53, s53, 157696
    v_add_u32 v4, s53, v3
    v_mov_b32 v5, -1
    ds_write_b32 v4, v5
    v_add_u32 v4, 158720, v3
    v_mov_b32 v5, 0
    ds_write_b32 v4, v5
    v_mov_b32 v232, 0
    v_mov_b32 v233, 0
    v_mov_b32 v234, 0
    v_mov_b32 v235, 0
    v_lshlrev_b32 v244, 4, v244
    v_add_u32 v244, 19202048, v244
    s_waitcnt vmcnt(7)
    v_readfirstlane_b32 s62, v243
    s_nop 0
    s_mul_i32 s62, s62, 1664525
    s_add_u32 s62, s62, 1013904223
    s_mul_i32 s63, s62, 0x9E3779B1
    s_xor_b32 s63, s63, 0x5bd1e995
    s_waitcnt vmcnt(6)
    v_dot2c_f32_bf16 v232, s3, v204
    v_dot2c_f32_bf16 v233, v204, v204
    v_dot2c_f32_bf16 v234, s3, v205
    v_dot2c_f32_bf16 v235, v205, v205
    v_dot2c_f32_bf16 v232, s3, v206
    v_dot2c_f32_bf16 v233, v206, v206
    v_dot2c_f32_bf16 v234, s3, v207
    v_dot2c_f32_bf16 v235, v207, v207
    s_waitcnt vmcnt(5)
    v_dot2c_f32_bf16 v232, s3, v208
    v_dot2c_f32_bf16 v233, v208, v208
    v_dot2c_f32_bf16 v234, s3, v209
    v_dot2c_f32_bf16 v235, v209, v209
    v_dot2c_f32_bf16 v232, s3, v210
    v_dot2c_f32_bf16 v233, v210, v210
    v_dot2c_f32_bf16 v234, s3, v211
    v_dot2c_f32_bf16 v235, v211, v211
    s_waitcnt vmcnt(4)
    v_dot2c_f32_bf16 v232, s3, v212
    v_dot2c_f32_bf16 v233, v212, v212
    v_dot2c_f32_bf16 v234, s3, v213
    v_dot2c_f32_bf16 v235, v213, v213
    v_dot2c_f32_bf16 v232, s3, v214
    v_dot2c_f32_bf16 v233, v214, v214
    v_dot2c_f32_bf16 v234, s3, v215
    v_dot2c_f32_bf16 v235, v215, v215
    s_waitcnt vmcnt(3)
    v_dot2c_f32_bf16 v232, s3, v216
    v_dot2c_f32_bf16 v233, v216, v216
    v_dot2c_f32_bf16 v234, s3, v217
    v_dot2c_f32_bf16 v235, v217, v217
    v_dot2c_f32_bf16 v232, s3, v218
    v_dot2c_f32_bf16 v233, v218, v218
    v_dot2c_f32_bf16 v234, s3, v219
    v_dot2c_f32_bf16 v235, v219, v219
    s_waitcnt vmcnt(2)
    v_dot2c_f32_bf16 v232, s3, v220
    v_dot2c_f32_bf16 v233, v220, v220
    v_dot2c_f32_bf16 v234, s3, v221
    v_dot2c_f32_bf16 v235, v221, v221
    v_dot2c_f32_bf16 v232, s3, v222
    v_dot2c_f32_bf16 v233, v222, v222
    v_dot2c_f32_bf16 v234, s3, v223
    v_dot2c_f32_bf16 v235, v223, v223
    s_waitcnt vmcnt(1)
    v_dot2c_f32_bf16 v232, s3, v224
    v_dot2c_f32_bf16 v233, v224, v224
    v_dot2c_f32_bf16 v234, s3, v225
    v_dot2c_f32_bf16 v235, v225, v225
    v_dot2c_f32_bf16 v232, s3, v226
    v_dot2c_f32_bf16 v233, v226, v226
    v_dot2c_f32_bf16 v234, s3, v227
    v_dot2c_f32_bf16 v235, v227, v227
    s_waitcnt vmcnt(0)
    v_dot2c_f32_bf16 v232, s3, v228
    v_dot2c_f32_bf16 v233, v228, v228
    v_dot2c_f32_bf16 v234, s3, v229
    v_dot2c_f32_bf16 v235, v229, v229
    v_dot2c_f32_bf16 v232, s3, v230
    v_dot2c_f32_bf16 v233, v230, v230
    v_dot2c_f32_bf16 v234, s3, v231
    v_dot2c_f32_bf16 v235, v231, v231
    v_mov_b32 v238, s62
    v_mov_b32 v239, s63
    s_nop 0
    v_add_f32 v232, v232, v234
    v_add_f32 v233, v233, v235
    s_nop 0
    v_add_f32_dpp v232, v232, v232 quad_perm:[1,0,3,2] row_mask:0xf bank_mask:0xf
    v_add_f32_dpp v233, v233, v233 quad_perm:[1,0,3,2] row_mask:0xf bank_mask:0xf
    s_nop 0
    v_add_f32_dpp v232, v232, v232 quad_perm:[2,3,0,1] row_mask:0xf bank_mask:0xf
    v_add_f32_dpp v233, v233, v233 quad_perm:[2,3,0,1] row_mask:0xf bank_mask:0xf
    s_nop 0
    v_add_f32_dpp v232, v232, v232 row_half_mirror row_mask:0xf bank_mask:0xf
    v_add_f32_dpp v233, v233, v233 row_half_mirror row_mask:0xf bank_mask:0xf
    s_nop 0
    v_mul_f32 v232, 0x3b124925, v232
    v_mul_f32 v233, 0x3b124925, v233
    v_fma_f32 v233, -v232, v232, v233
    v_max_f32 v233, 0, v233
    v_cvt_pk_bf16_f32 v237, -v232, -v232
    v_cvt_pk_bf16_f32 v236, v233, v233
    v_and_b32 v236, 0xffff0000, v236
    v_add_f32 v236, 0x3727c5ac, v236
    v_cvt_pk_bf16_f32 v236, v236, v236
    v_and_b32 v236, 0xffff0000, v236
    v_sqrt_f32 v236, v236
    s_nop 0
    v_cvt_pk_bf16_f32 v236, v236, v236
    v_and_b32 v236, 0xffff0000, v236
    v_rcp_f32 v236, v236
    s_mov_b32 exec_lo, 0x01010101
    s_mov_b32 exec_hi, 0x01010101
    buffer_store_dwordx4 v[236:239], v244, s[36:39], 0 offen sc1
    s_mov_b64 exec, -1
    s_and_b32 s53, s2, 31
    s_lshl_b32 s54, s48, 5
    s_add_u32 s53, s53, s54
    s_lshr_b32 s54, s53, 4
    s_mul_i32 s54, s54, 589824
    s_and_b32 s53, s53, 15
    s_lshl_b32 s53, s53, 11
    s_add_u32 s53, s53, s54
    s_add_u32 s56, s53, 6406144
    v_lshlrev_b32 v5, 4, v0
    v_mov_b32 v16, -1
    v_mov_b32 v17, -1
    v_mov_b32 v18, -1
    v_mov_b32 v19, -1
    buffer_store_dwordx4 v[16:19], v5, s[36:39], s56 offen offset:0 sc1
    buffer_store_dwordx4 v[16:19], v5, s[36:39], s56 offen offset:1024 sc1
    s_add_u32 s56, s56, 147456
    buffer_store_dwordx4 v[16:19], v5, s[36:39], s56 offen offset:0 sc1
    buffer_store_dwordx4 v[16:19], v5, s[36:39], s56 offen offset:1024 sc1
    s_add_u32 s56, s56, 147456
    buffer_store_dwordx4 v[16:19], v5, s[36:39], s56 offen offset:0 sc1
    buffer_store_dwordx4 v[16:19], v5, s[36:39], s56 offen offset:1024 sc1
    s_add_u32 s56, s56, 147456
    buffer_store_dwordx4 v[16:19], v5, s[36:39], s56 offen offset:0 sc1
    buffer_store_dwordx4 v[16:19], v5, s[36:39], s56 offen offset:1024 sc1
    s_add_u32 s56, s56, 147456
    s_cmp_lg_u32 s48, 0
    s_cbranch_scc1 S_NOONE
    v_lshlrev_b32 v3, 2, v1
    v_lshl_add_u32 v3, v2, 10, v3
    v_mov_b32 v4, s3
    buffer_store_dword v4, v3, s[36:39], s47 offen sc1
S_NOONE:
    s_waitcnt vmcnt(0) lgkmcnt(0)
    s_barrier
    s_mov_b32 s32, s14
    s_mov_b32 s33, s15
    s_mov_b32 s34, 1605632
    s_mov_b32 s35, 0x00020000
    v_mov_b32 v249, 0
    s_mov_b32 s41, 0
    s_mov_b32 s46, 3
    s_cmp_lt_u32 s48, 4
    s_waitcnt vmcnt(0)
    s_cbranch_scc1 ATT
    s_mov_b32 s55, s60
    s_waitcnt lgkmcnt(0)
    s_mov_b32 s24, s14
    s_mov_b32 s25, s15
    s_mov_b32 s26, 1605632
    s_mov_b32 s27, 0x00020000
    s_mov_b32 s28, s8
    s_mov_b32 s29, s9
    s_mov_b32 s30, 401408
    s_mov_b32 s31, 0x00020000
    s_mul_i32 s53, s55, 100352
    v_lshl_add_u32 v3, v0, 4, s53
    s_mul_i32 s53, s55, 25088
    v_lshl_add_u32 v4, v0, 4, s53
    s_and_b32 s56, s2, 7
    s_mul_i32 s56, s56, 12288
    s_mov_b32 s61, 4
WARM_L:
    buffer_load_dwordx4 v[16:19], v3, s[24:27], s56 offen offset:0
    buffer_load_dwordx4 v[20:23], v3, s[24:27], s56 offen offset:1024
    buffer_load_dwordx4 v[24:27], v3, s[24:27], s56 offen offset:2048
    buffer_load_dwordx4 v[28:31], v3, s[24:27], s56 offen offset:3072
    s_lshr_b32 s53, s56, 2
    buffer_load_dwordx4 v[32:35], v4, s[28:31], s53 offen
    s_add_u32 s56, s56, 4096
    s_cmp_eq_u32 s56, 102400
    s_cselect_b32 s56, 0, s56
    s_sub_u32 s61, s61, 1
    s_cmp_lg_u32 s61, 0
    s_waitcnt vmcnt(10)
    s_cbranch_scc1 WARM_L
    s_endpgm
CODE_END:
.section .rodata,"a"
.p2align 6
.amdhsa_kernel parallel_sum__softmax_full_mha__dense_activation_relu__prompt_kernel
  .amdhsa_next_free_vgpr 256
  .amdhsa_next_free_sgpr 102
  .amdhsa_accum_offset 256
  .amdhsa_group_segment_fixed_size 0
  .amdhsa_kernarg_size 72
  .amdhsa_user_sgpr_count 2
  .amdhsa_user_sgpr_kernarg_segment_ptr 1
  .amdhsa_system_sgpr_workgroup_id_x 1
.end_amdhsa_kernel
```
